```python
import torch

def _softmax(x, axis=-1):
    return torch.softmax(x, dim=axis)
def _gelu(x):
    return torch.nn.functional.gelu(x, approximate="tanh")
def _silu(x):
    return torch.nn.functional.silu(x)
def _sigmoid(x):
    return torch.sigmoid(x)
def _layernorm(x, axis=-1, eps=1e-5):
    m = x.mean(dim=axis, keepdim=True)
    v = x.var(dim=axis, keepdim=True, unbiased=False)
    return (x - m) / torch.sqrt(v + eps)
def _scatter_add(tgt, idx, src, axis=0):
    return tgt.clone().index_add_(axis, idx, src)
def _segment_sum(src, seg, n):
    out = torch.zeros((n,) + src.shape[1:], dtype=src.dtype)
    return out.index_add_(0, seg, src)
def _pad(x, pw):
    flat = tuple(v for pair in reversed(pw) for v in pair)
    return torch.nn.functional.pad(x, flat)

kernel_name = 'concat_heads__linear_kernel_hedgehog__ssm_conv_s4d__prompt'

def setup_inputs():

    _w = (lambda a: (lambda t: t.to(torch.bfloat16) if t.is_floating_point() else t)(torch.as_tensor(a)))
    def _A_setup():
        B, S, D, H = 1, 2048, 512, 32
        Dh = D // H
        return {
            "x": _w((lambda *s: torch.randn(*s, dtype=torch.bfloat16) * 0.4)(B, S, D)),
            "wqkv": _w((lambda *s: torch.randn(*s, dtype=torch.bfloat16) * 0.4)(D, 3 * D)),
            "w_phi": _w((lambda *s: torch.randn(*s, dtype=torch.bfloat16) * 0.4)(H, Dh, Dh) * (Dh ** -0.5)),
            "wo": _w((lambda *s: torch.randn(*s, dtype=torch.bfloat16) * 0.05)(D, D)),
        }
    _A_in = _A_setup()

    def _B_setup():
        Bsz, L, D, N = 1, 2048, 512, 128
        return {
            "u": _w((lambda *s: torch.randn(*s, dtype=torch.bfloat16) * 0.05)(Bsz, L, D)),
            "log_A_real": _w((lambda *s: torch.randn(*s, dtype=torch.bfloat16) * 3.2)(D, N) * 0.5),
            "A_imag": _w((lambda *s: torch.randn(*s, dtype=torch.bfloat16) * 0.2)(D, N) * 3.14),
            "C_real": _w((lambda *s: torch.randn(*s, dtype=torch.bfloat16) * 3.2)(D, N) / N ** 0.5),
            "C_imag": _w((lambda *s: torch.randn(*s, dtype=torch.bfloat16) * 3.2)(D, N) / N ** 0.5),
            "log_dt": _w((lambda *s: torch.randn(*s, dtype=torch.bfloat16) * 0.2)(D) * 0.5 - 4.0),
            "D_skip": _w((lambda *s: torch.randn(*s, dtype=torch.bfloat16) * 0.4)(D)),
        }
    _B_in = _B_setup()

    return {
        "A_x": _A_in["x"],
        "A_wqkv": _A_in["wqkv"],
        "A_w_phi": _A_in["w_phi"],
        "A_wo": _A_in["wo"],
        "B_u": _B_in["u"],
        "B_log_A_real": _B_in["log_A_real"],
        "B_A_imag": _B_in["A_imag"],
        "B_C_real": _B_in["C_real"],
        "B_C_imag": _B_in["C_imag"],
        "B_log_dt": _B_in["log_dt"],
        "B_D_skip": _B_in["D_skip"],
    }

def reference(A_x, A_wqkv, A_w_phi, A_wo, B_u, B_log_A_real, B_A_imag, B_C_real, B_C_imag, B_log_dt, B_D_skip):
    def _A_ref(x, wqkv, w_phi, wo):
        B, S, D = x.shape
        H = 32; Dh = D // H
        qkv = (lambda x, *d: x.permute(*d))((x @ wqkv).reshape(B, S, 3, H, Dh), 2, 0, 3, 1, 4)
        q, k, v = qkv[0], qkv[1], qkv[2]
        pq = torch.einsum("bhsd,hdf->bhsf", q, w_phi)
        pk = torch.einsum("bhsd,hdf->bhsf", k, w_phi)
        phi_q = torch.concatenate([_softmax(pq, axis=-1), _softmax(-pq, axis=-1)], axis=-1)
        phi_k = torch.concatenate([_softmax(pk, axis=-1), _softmax(-pk, axis=-1)], axis=-1)
        kv = torch.einsum("bhsf,bhsd->bhfd", phi_k, v)
        z  = torch.einsum("bhsf->bhf", phi_k)
        num = torch.einsum("bhqf,bhfd->bhqd", phi_q, kv)
        den = torch.einsum("bhqf,bhf->bhq", phi_q, z)[..., None] + 1e-6
        o = num / den
        return (lambda x, *d: x.permute(*d))(o, 0, 2, 1, 3).reshape(B, S, D) @ wo

    def _B_ref(u, log_A_real, A_imag, C_real, C_imag, log_dt, D_skip):
        L = u.shape[1]
        dt = torch.exp(log_dt)
        A = -torch.exp(log_A_real) + 1j * A_imag
        C = (C_real + 1j * C_imag) * dt[:, None]
        pos = (lambda x, dt: x.to(dt))(torch.arange(L), log_dt.dtype)
        P = torch.exp((A * dt[:, None])[:, :, None] * pos[None, None, :])
        K = 2.0 * torch.einsum("dn,dnl->dl", C, P).real
        L2 = 2 * L
        u_t = (lambda x, *d: x.permute(*d))(u, 0, 2, 1)
        Kf = (lambda x, *a, **k: torch.fft.rfft(x.float(), *a, **k))(K, L2)
        Uf = (lambda x, *a, **k: torch.fft.rfft(x.float(), *a, **k))(u_t, L2)
        y = (lambda x, *a, **k: torch.fft.irfft(x, *a, **k).to(torch.bfloat16))(Uf * Kf[None, :, :], L2)[:, :, :L]
        y = (lambda x, *d: x.permute(*d))(y, 0, 2, 1)
        return y + u * D_skip[None, None, :]

    a = _A_ref(A_x, A_wqkv, A_w_phi, A_wo)
    b = _B_ref(B_u, B_log_A_real, B_A_imag, B_C_real, B_C_imag, B_log_dt, B_D_skip)
    return torch.concatenate([a, b], axis=-1)
```

```asm
; @launch grid=(256,1,1) block=(512,1,1) lds=163840
.amdgcn_target "amdgcn-amd-amdhsa--gfx950"
.text
.globl concat_heads__linear_kernel_hedgehog__ssm_conv_s4d__prompt_kernel
.p2align 8
.type concat_heads__linear_kernel_hedgehog__ssm_conv_s4d__prompt_kernel,@function
concat_heads__linear_kernel_hedgehog__ssm_conv_s4d__prompt_kernel:
s_cmp_gt_u32 s2, 255
s_cbranch_scc1 L_END
s_load_dwordx16 s[4:19], s[0:1], 0
s_load_dwordx8 s[20:27], s[0:1], 64
s_load_dwordx4 s[28:31], s[0:1], 96
v_lshrrev_b32 v1, 6, v0
s_nop 0
v_readfirstlane_b32 s70, v1
v_and_b32 v1, 63, v0
s_cmp_gt_u32 s2, 127
s_cbranch_scc1 L_B
s_mov_b32 s64, 0
s_bfe_u32 s3, s2, 0x20003
s_lshl_b32 s3, s3, 0
s_add_u32 s64, s64, s3
s_bfe_u32 s3, s2, 0x10000
s_lshl_b32 s3, s3, 2
s_add_u32 s64, s64, s3
s_mov_b32 s65, 0
s_bfe_u32 s3, s2, 0x20005
s_lshl_b32 s3, s3, 0
s_add_u32 s65, s65, s3
s_bfe_u32 s3, s2, 0x20001
s_lshl_b32 s3, s3, 2
s_add_u32 s65, s65, s3
s_mov_b32 s68, 0
s_bfe_u32 s3, s65, 0x20000
s_lshl_b32 s3, s3, 1
s_add_u32 s68, s68, s3
s_bfe_u32 s3, s64, 0x20000
s_lshl_b32 s3, s3, 1
s_add_u32 s68, s68, s3
s_and_b32 s68, s68, 7
s_lshl_b32 s71, s70, 12
s_mov_b32 s73, 0
s_bfe_u32 s3, s65, 0x40000
s_lshl_b32 s3, s3, 17
s_add_u32 s73, s73, s3
s_bfe_u32 s3, s70, 0x30000
s_lshl_b32 s3, s3, 14
s_add_u32 s73, s73, s3
v_bfe_u32 v120, v1, 0, 3
v_lshlrev_b32 v2, 4, v120
v_bfe_u32 v120, v1, 4, 2
v_lshlrev_b32 v3, 4, v120
v_xor_b32 v3, v2, v3
v_bfe_u32 v120, v1, 4, 1
v_lshlrev_b32 v4, 6, v120
v_xor_b32 v4, v2, v4
s_mov_b32 s60, 1048576
s_bfe_u32 s3, s65, 0x40000
s_lshl_b32 s3, s3, 17
s_add_u32 s60, s60, s3
s_bfe_u32 s3, s70, 0x20000
s_lshl_b32 s3, s3, 15
s_add_u32 s60, s60, s3
s_bfe_u32 s3, s64, 0x30000
s_lshl_b32 s3, s3, 12
s_add_u32 s60, s60, s3
s_bfe_u32 s3, s70, 0x10002
s_lshl_b32 s3, s3, 11
s_add_u32 s60, s60, s3
s_mov_b32 s61, 65536
s_bfe_u32 s3, s64, 0x30000
s_lshl_b32 s3, s3, 16
s_add_u32 s61, s61, s3
s_bfe_u32 s3, s65, 0x40000
s_lshl_b32 s3, s3, 12
s_add_u32 s61, s61, s3
s_bfe_u32 s3, s70, 0x30000
s_lshl_b32 s3, s3, 9
s_add_u32 s61, s61, s3
s_mov_b32 s62, 589824
s_bfe_u32 s3, s64, 0x30000
s_lshl_b32 s3, s3, 12
s_add_u32 s62, s62, s3
s_bfe_u32 s3, s70, 0x30000
s_lshl_b32 s3, s3, 9
s_add_u32 s62, s62, s3
s_bfe_u32 s3, s65, 0x40000
s_lshl_b32 s3, s3, 5
s_add_u32 s62, s62, s3
v_mov_b32 v96, -1
v_mov_b32 v97, -1
v_mov_b32 v98, -1
v_mov_b32 v99, -1
v_lshrrev_b32 v5, 3, v1
v_lshl_add_u32 v2, v5, 10, v3
v_add_u32 v2, s73, v2
v_xor_b32 v3, 64, v2
v_add_u32 v3, 0x1400, v3
s_mul_i32 s73, s70, 24576
s_lshl_b32 s3, s64, 7
s_add_u32 s73, s73, s3
v_mul_u32_u24 v5, 0xc00, v5
v_add3_u32 v4, v4, v5, s73
v_lshlrev_b32 v5, 4, v1
s_waitcnt lgkmcnt(0)
s_mov_b32 s32, s4
s_mov_b32 s33, s5
s_mov_b32 s34, 0x200000
s_mov_b32 s35, 0x20000
s_mov_b32 s36, s6
s_mov_b32 s37, s7
s_mov_b32 s38, 0x180000
s_mov_b32 s39, 0x20000
s_mov_b32 s48, s30
s_mov_b32 s49, s31
s_mov_b32 s50, 0x300000
s_mov_b32 s51, 0x20000
s_mov_b32 exec_hi, 0
buffer_store_dwordx4 v[96:99], v5, s[48:51], s61 offen sc1
s_mov_b32 exec_lo, 3
buffer_store_dwordx4 v[96:99], v5, s[48:51], s62 offen sc1
s_cmp_lg_u32 s70, 7
s_cbranch_scc1 L_A1
s_mov_b32 s73, 655360
s_bfe_u32 s3, s65, 0x40000
s_lshl_b32 s3, s3, 9
s_add_u32 s73, s73, s3
s_bfe_u32 s3, s64, 0x30000
s_lshl_b32 s3, s3, 6
s_add_u32 s73, s73, s3
s_mov_b32 exec_lo, 15
buffer_store_dwordx4 v[96:99], v5, s[48:51], s73 offen sc1
L_A1:
s_mov_b64 exec, -1
s_lshl_b32 s75, s68, 7
s_mul_i32 s74, s68, 0x30000
s_add_u32 m0, s71, 0
s_add_u32 s68, s68, 1
s_and_b32 s68, s68, 7
buffer_load_dwordx4 v2, s[32:35], s75 offen lds
buffer_load_dwordx4 v4, s[36:39], s74 offen offset:1024 lds
buffer_load_dwordx4 v3, s[32:35], s75 offen offset:3072 lds
buffer_load_dwordx4 v4, s[36:39], s74 offen offset:2048 lds
s_mov_b32 s40, s8
s_mov_b32 s41, s9
s_mov_b32 s42, 0x4000
s_mov_b32 s43, 0x20000
s_and_b32 s3, s70, 1
s_lshl_b32 s3, s3, 10
s_add_u32 m0, s3, 131072
s_lshl_b32 s73, s64, 11
s_add_u32 s3, s3, s73
buffer_load_dwordx4 v5, s[40:43], s3 offen lds
s_barrier
s_mov_b32 s73, 131072
s_bfe_u32 s3, s70, 0x20000
s_lshl_b32 s3, s3, 12
s_add_u32 s73, s73, s3
s_bfe_u32 s3, s70, 0x10002
s_lshl_b32 s3, s3, 11
s_add_u32 s73, s73, s3
v_add_u32 v104, s73, v5
s_mov_b32 s73, 65536
s_bfe_u32 s3, s70, 0x10002
s_lshl_b32 s3, s3, 14
s_add_u32 s73, s73, s3
s_bfe_u32 s3, s70, 0x20000
s_lshl_b32 s3, s3, 11
s_add_u32 s73, s73, s3
v_mov_b32 v105, s73
v_bfe_u32 v120, v1, 1, 2
v_lshl_add_u32 v105, v120, 4, v105
v_bfe_u32 v120, v1, 0, 5
v_lshl_add_u32 v105, v120, 6, v105
v_bfe_u32 v120, v1, 5, 1
v_lshl_add_u32 v105, v120, 13, v105
v_xor_b32 v106, 16, v105
v_xor_b32 v107, 32, v105
v_xor_b32 v108, 48, v105
s_mov_b32 s73, 0
s_bfe_u32 s3, s70, 0x10000
s_lshl_b32 s3, s3, 5
s_add_u32 s73, s73, s3
v_mov_b32 v109, s73
v_bfe_u32 v120, v1, 1, 1
v_lshl_add_u32 v109, v120, 4, v109
v_bfe_u32 v120, v1, 3, 2
v_lshlrev_b32 v110, 4, v120
v_xor_b32 v109, v109, v110
s_mov_b32 s73, 65536
s_bfe_u32 s3, s70, 0x20001
s_lshl_b32 s3, s3, 13
s_add_u32 s73, s73, s3
v_add_u32 v109, s73, v109
v_bfe_u32 v120, v1, 2, 3
v_lshl_add_u32 v109, v120, 6, v109
v_bfe_u32 v120, v1, 5, 1
v_lshl_add_u32 v109, v120, 10, v109
v_bfe_u32 v120, v1, 0, 1
v_lshl_add_u32 v109, v120, 3, v109
s_mov_b32 s73, 131072
s_bfe_u32 s3, s70, 0x10002
s_lshl_b32 s3, s3, 11
s_add_u32 s73, s73, s3
s_bfe_u32 s3, s70, 0x10001
s_lshl_b32 s3, s3, 8
s_add_u32 s73, s73, s3
v_mov_b32 v110, s73
v_bfe_u32 v120, v1, 4, 2
v_lshl_add_u32 v110, v120, 9, v110
v_bfe_u32 v120, v1, 0, 4
v_lshl_add_u32 v110, v120, 4, v110
v_bfe_u32 v120, v1, 4, 2
v_lshlrev_b32 v112, 3, v120
v_mov_b32 v111, v112
v_bfe_u32 v120, v1, 0, 4
v_lshl_add_u32 v111, v120, 5, v111
v_bfe_u32 v120, v1, 0, 4
v_lshlrev_b32 v113, 4, v120
v_bfe_u32 v120, v1, 4, 2
v_lshlrev_b32 v114, 6, v120
v_xor_b32 v113, v113, v114
s_mov_b32 s73, 0
s_bfe_u32 s3, s64, 0x20000
s_lshl_b32 s3, s3, 8
s_add_u32 s73, s73, s3
s_bfe_u32 s3, s70, 0x20000
s_lshl_b32 s3, s3, 14
s_add_u32 s73, s73, s3
v_add_u32 v113, s73, v113
v_bfe_u32 v120, v1, 4, 2
v_lshl_add_u32 v113, v120, 10, v113
s_mov_b32 s73, 0
s_bfe_u32 s3, s70, 0x20000
s_lshl_b32 s3, s3, 9
s_add_u32 s73, s73, s3
v_mov_b32 v114, s73
v_bfe_u32 v120, v1, 4, 2
v_lshl_add_u32 v114, v120, 12, v114
v_bfe_u32 v120, v1, 0, 4
v_lshl_add_u32 v114, v120, 4, v114
v_mov_b32 v115, s73
v_bfe_u32 v120, v1, 1, 2
v_lshl_add_u32 v115, v120, 7, v115
v_bfe_u32 v120, v1, 4, 2
v_lshl_add_u32 v115, v120, 5, v115
v_bfe_u32 v120, v1, 0, 1
v_lshl_add_u32 v115, v120, 4, v115
s_mov_b32 s73, 147456
s_bfe_u32 s3, s70, 0x20000
s_lshl_b32 s3, s3, 9
s_add_u32 s73, s73, s3
v_mov_b32 v116, s73
v_bfe_u32 v120, v1, 5, 1
v_lshl_add_u32 v116, v120, 8, v116
v_bfe_u32 v120, v1, 0, 4
v_lshl_add_u32 v116, v120, 4, v116
v_bfe_u32 v120, v1, 4, 1
v_lshl_add_u32 v116, v120, 3, v116
s_mov_b32 s73, 151552
s_bfe_u32 s3, s70, 0x20000
s_lshl_b32 s3, s3, 5
s_add_u32 s73, s73, s3
v_mov_b32 v117, s73
v_bfe_u32 v120, v1, 1, 2
v_lshl_add_u32 v117, v120, 8, v117
v_bfe_u32 v120, v1, 0, 1
v_lshl_add_u32 v117, v120, 4, v117
v_bfe_u32 v120, v1, 4, 1
v_lshl_add_u32 v117, v120, 3, v117
v_bfe_u32 v120, v1, 5, 1
v_lshl_add_u32 v117, v120, 7, v117
s_mov_b32 s73, 147456
s_bfe_u32 s3, s70, 0x10002
s_lshl_b32 s3, s3, 11
s_add_u32 s73, s73, s3
v_mov_b32 v118, s73
v_bfe_u32 v120, v1, 5, 1
v_lshl_add_u32 v118, v120, 10, v118
v_bfe_u32 v120, v1, 3, 2
v_lshl_add_u32 v118, v120, 7, v118
v_bfe_u32 v120, v1, 0, 2
v_lshl_add_u32 v118, v120, 5, v118
s_mov_b32 s73, 151552
s_bfe_u32 s3, s70, 0x10002
s_lshl_b32 s3, s3, 7
s_add_u32 s73, s73, s3
v_mov_b32 v119, s73
v_bfe_u32 v120, v1, 0, 2
v_lshl_add_u32 v119, v120, 8, v119
v_bfe_u32 v120, v1, 5, 1
v_lshl_add_u32 v119, v120, 6, v119
v_mov_b32 v120, 152592
s_mov_b32 vcc_lo, 0x00f0000f
s_mov_b32 vcc_hi, 0xf0000f00
v_cndmask_b32 v119, v120, v119, vcc
s_mov_b32 vcc_lo, 0x0f0f0f0f
s_mov_b32 vcc_hi, 0xf0f0f0f0
v_cndmask_b32 v118, v120, v118, vcc
v_lshl_add_u32 v120, v0, 1, v120
v_mov_b32 v121, 0
ds_write_b16 v120, v121
s_mov_b32 s73, 0
s_bfe_u32 s3, s70, 0x20001
s_lshl_b32 s3, s3, 6
s_add_u32 s73, s73, s3
v_bfe_u32 v120, v1, 2, 2
v_lshlrev_b32 v124, 6, v120
v_xor_b32 v124, s73, v124
v_bfe_u32 v120, v1, 0, 1
v_lshl_add_u32 v124, v120, 5, v124
v_bfe_u32 v120, v1, 1, 1
v_lshl_add_u32 v124, v120, 3, v124
v_bfe_u32 v120, v1, 4, 1
v_lshl_add_u32 v124, v120, 4, v124
v_bfe_u32 v120, v1, 2, 2
v_lshl_add_u32 v124, v120, 8, v124
v_bfe_u32 v120, v1, 5, 1
v_lshl_add_u32 v124, v120, 12, v124
v_add_u32 v125, 65536, v124
v_add_u32 v126, 98304, v124
s_mov_b32 s73, 65536
s_bfe_u32 s3, s70, 0x10000
s_lshl_b32 s3, s3, 15
s_add_u32 s73, s73, s3
v_add_u32 v127, s73, v5
v_bfe_u32 v120, v1, 0, 5
v_lshlrev_b32 v11, 11, v120
v_bfe_u32 v120, v1, 5, 1
v_lshl_add_u32 v11, v120, 5, v11
s_mov_b32 s67, 65536
s_bfe_u32 s3, s70, 0x10002
s_lshl_b32 s3, s3, 15
s_add_u32 s67, s67, s3
s_bfe_u32 s3, s70, 0x20000
s_lshl_b32 s3, s3, 12
s_add_u32 s67, s67, s3
v_add_u32 v12, s67, v5
s_lshl_b32 s75, s68, 7
s_mul_i32 s74, s68, 0x30000
s_add_u32 m0, s71, 32768
s_add_u32 s68, s68, 1
s_and_b32 s68, s68, 7
buffer_load_dwordx4 v2, s[32:35], s75 offen lds
buffer_load_dwordx4 v4, s[36:39], s74 offen offset:1024 lds
buffer_load_dwordx4 v3, s[32:35], s75 offen offset:3072 lds
buffer_load_dwordx4 v4, s[36:39], s74 offen offset:2048 lds
s_mov_b32 s44, s10
s_mov_b32 s45, s11
s_mov_b32 s46, 0x80000
s_mov_b32 s47, 0x20000
s_mov_b32 s52, s26
s_mov_b32 s53, s27
s_mov_b32 s54, 0x400000
s_mov_b32 s55, 0x20000
s_mov_b32 s56, s28
s_mov_b32 s57, s29
s_mov_b32 s58, 0x100
s_mov_b32 s59, 0x20000
s_mov_b32 s76, 0x3fb8aa3b
s_and_b32 s3, s70, 3
s_lshl_b32 s73, s3, 13
s_lshl_b32 s69, s3, 12
s_lshr_b32 s66, s70, 2
s_lshl_b32 s66, s66, 16
s_mov_b32 s63, 0x40000
s_or_b32 s66, s66, s63
v_bfe_u32 v120, v1, 1, 3
v_lshlrev_b32 v6, 4, v120
v_bfe_u32 v120, v1, 5, 1
v_lshlrev_b32 v7, 4, v120
v_xor_b32 v6, v6, v7
v_add_u32 v6, s73, v6
v_bfe_u32 v120, v1, 0, 3
v_lshl_add_u32 v6, v120, 7, v6
v_bfe_u32 v120, v1, 3, 1
v_lshl_add_u32 v6, v120, 11, v6
v_bfe_u32 v120, v1, 3, 1
v_lshl_add_u32 v6, v120, 10, v6
v_bfe_u32 v120, v1, 4, 1
v_lshl_add_u32 v6, v120, 12, v6
v_xor_b32 v7, 32, v6
v_xor_b32 v8, 64, v6
v_xor_b32 v9, 0x60, v6
s_mov_b32 s73, 0
s_bfe_u32 s3, s70, 0x10002
s_lshl_b32 s3, s3, 6
s_add_u32 s73, s73, s3
v_bfe_u32 v120, v1, 3, 1
v_lshlrev_b32 v10, 6, v120
v_xor_b32 v10, s73, v10
v_bfe_u32 v120, v1, 4, 1
v_lshl_add_u32 v10, v120, 5, v10
v_bfe_u32 v120, v1, 0, 2
v_lshl_add_u32 v10, v120, 3, v10
v_bfe_u32 v120, v1, 2, 2
v_lshl_add_u32 v10, v120, 7, v10
v_bfe_u32 v120, v1, 5, 1
v_lshl_add_u32 v10, v120, 12, v10
s_mov_b32 s73, 131072
s_bfe_u32 s3, s70, 0x10002
s_lshl_b32 s3, s3, 10
s_add_u32 s73, s73, s3
v_mov_b32 v15, s73
v_bfe_u32 v120, v1, 0, 1
v_lshl_add_u32 v15, v120, 9, v15
v_bfe_u32 v120, v1, 1, 1
v_lshl_add_u32 v15, v120, 3, v15
v_bfe_u32 v120, v1, 4, 1
v_lshl_add_u32 v15, v120, 4, v15
v_bfe_u32 v120, v1, 2, 2
v_lshl_add_u32 v15, v120, 5, v15
v_bfe_u32 v120, v1, 5, 1
v_lshl_add_u32 v15, v120, 7, v15
v_mov_b32 v13, 1
s_mov_b32 s73, 0
s_bfe_u32 s3, s2, 0x10000
s_lshl_b32 s3, s3, 7
s_add_u32 s73, s73, s3
v_bfe_u32 v120, v1, 0, 1
v_lshlrev_b32 v14, 7, v120
v_xor_b32 v14, s73, v14
s_mov_b32 s72, 0
s_bfe_u32 s3, s2, 0x20003
s_lshl_b32 s3, s3, 0
s_add_u32 s72, s72, s3
s_bfe_u32 s3, s70, 0x30000
s_lshl_b32 s3, s3, 2
s_add_u32 s72, s72, s3
s_mov_b32 s77, 0
s_bfe_u32 s3, s2, 0x60001
s_lshl_b32 s3, s3, 0
s_add_u32 s77, s77, s3
s_waitcnt vmcnt(4) lgkmcnt(0)
s_barrier
ds_read_b64_tr_b16 v[88:89], v15
ds_read_b64_tr_b16 v[90:91], v15 offset:256
ds_read_b128 v[128:131], v6 offset:0
ds_read_b64_tr_b16 v[48:49], v10 offset:1024
ds_read_b64_tr_b16 v[50:51], v10 offset:1536
ds_read_b64_tr_b16 v[52:53], v10 offset:2048
ds_read_b64_tr_b16 v[54:55], v10 offset:2560
ds_read_b128 v[132:135], v7 offset:0
ds_read_b64_tr_b16 v[56:57], v10 offset:9216
ds_read_b64_tr_b16 v[58:59], v10 offset:9728
ds_read_b64_tr_b16 v[60:61], v10 offset:10240
ds_read_b64_tr_b16 v[62:63], v10 offset:10752
ds_read_b128 v[136:139], v8 offset:0
ds_read_b64_tr_b16 v[64:65], v10 offset:17408
ds_read_b64_tr_b16 v[66:67], v10 offset:17920
ds_read_b64_tr_b16 v[68:69], v10 offset:18432
ds_read_b64_tr_b16 v[70:71], v10 offset:18944
s_waitcnt lgkmcnt(10)
v_mfma_f32_32x32x16_bf16 v[16:31], v[48:51], v[128:131], 0
ds_read_b128 v[140:143], v9 offset:0
ds_read_b64_tr_b16 v[72:73], v10 offset:25600
ds_read_b64_tr_b16 v[74:75], v10 offset:26112
ds_read_b64_tr_b16 v[76:77], v10 offset:26624
ds_read_b64_tr_b16 v[78:79], v10 offset:27136
v_mfma_f32_32x32x16_bf16 v[32:47], v[128:131], v[52:55], 0
s_waitcnt lgkmcnt(10)
v_mfma_f32_32x32x16_bf16 v[16:31], v[56:59], v[132:135], v[16:31]
v_mfma_f32_32x32x16_bf16 v[32:47], v[132:135], v[60:63], v[32:47]
s_lshl_b32 s75, s68, 7
s_mul_i32 s74, s68, 0x30000
s_add_u32 m0, s71, 65536
s_add_u32 s68, s68, 1
s_and_b32 s68, s68, 7
buffer_load_dwordx4 v2, s[32:35], s75 offen lds
buffer_load_dwordx4 v4, s[36:39], s74 offen offset:1024 lds
buffer_load_dwordx4 v3, s[32:35], s75 offen offset:3072 lds
buffer_load_dwordx4 v4, s[36:39], s74 offen offset:2048 lds
s_lshl_b32 s75, s68, 7
s_mul_i32 s74, s68, 0x30000
s_add_u32 m0, s71, 98304
s_add_u32 s68, s68, 1
s_and_b32 s68, s68, 7
buffer_load_dwordx4 v2, s[32:35], s75 offen lds
buffer_load_dwordx4 v4, s[36:39], s74 offen offset:1024 lds
buffer_load_dwordx4 v3, s[32:35], s75 offen offset:3072 lds
buffer_load_dwordx4 v4, s[36:39], s74 offen offset:2048 lds
s_cmp_lg_u32 s72, 0
s_cbranch_scc1 L_M0
s_mov_b64 exec, 1
buffer_atomic_add v13, v14, s[56:59], 0 offen sc1
s_mov_b64 exec, -1
L_M0:
s_waitcnt vmcnt(8) lgkmcnt(0)
s_barrier
ds_read_b128 v[144:147], v6 offset:32768
ds_read_b64_tr_b16 v[48:49], v10 offset:33792
ds_read_b64_tr_b16 v[50:51], v10 offset:34304
ds_read_b64_tr_b16 v[52:53], v10 offset:34816
ds_read_b64_tr_b16 v[54:55], v10 offset:35328
ds_read_b128 v[148:151], v7 offset:32768
ds_read_b64_tr_b16 v[56:57], v10 offset:41984
ds_read_b64_tr_b16 v[58:59], v10 offset:42496
ds_read_b64_tr_b16 v[60:61], v10 offset:43008
ds_read_b64_tr_b16 v[62:63], v10 offset:43520
v_mfma_f32_32x32x16_bf16 v[16:31], v[64:67], v[136:139], v[16:31]
s_lshl_b32 s75, s68, 7
s_mul_i32 s74, s68, 0x30000
s_add_u32 m0, s71, 0
s_add_u32 s68, s68, 1
s_and_b32 s68, s68, 7
buffer_load_dwordx4 v2, s[32:35], s75 offen lds
v_mfma_f32_32x32x16_bf16 v[32:47], v[136:139], v[68:71], v[32:47]
ds_read_b128 v[152:155], v8 offset:32768
ds_read_b64_tr_b16 v[64:65], v10 offset:50176
ds_read_b64_tr_b16 v[66:67], v10 offset:50688
ds_read_b64_tr_b16 v[68:69], v10 offset:51200
ds_read_b64_tr_b16 v[70:71], v10 offset:51712
v_mfma_f32_32x32x16_bf16 v[16:31], v[72:75], v[140:143], v[16:31]
buffer_load_dwordx4 v4, s[36:39], s74 offen offset:1024 lds
v_mfma_f32_32x32x16_bf16 v[32:47], v[140:143], v[76:79], v[32:47]
s_waitcnt lgkmcnt(10)
v_mfma_f32_32x32x16_bf16 v[16:31], v[48:51], v[144:147], v[16:31]
ds_read_b128 v[156:159], v9 offset:32768
ds_read_b64_tr_b16 v[72:73], v10 offset:58368
ds_read_b64_tr_b16 v[74:75], v10 offset:58880
ds_read_b64_tr_b16 v[76:77], v10 offset:59392
ds_read_b64_tr_b16 v[78:79], v10 offset:59904
buffer_load_dwordx4 v3, s[32:35], s75 offen offset:3072 lds
v_mfma_f32_32x32x16_bf16 v[32:47], v[144:147], v[52:55], v[32:47]
s_waitcnt lgkmcnt(10)
v_mfma_f32_32x32x16_bf16 v[16:31], v[56:59], v[148:151], v[16:31]
buffer_load_dwordx4 v4, s[36:39], s74 offen offset:2048 lds
v_mfma_f32_32x32x16_bf16 v[32:47], v[148:151], v[60:63], v[32:47]
v_xor_b32 v6, 0x10000, v6
v_xor_b32 v7, 0x10000, v7
v_xor_b32 v8, 0x10000, v8
v_xor_b32 v9, 0x10000, v9
v_xor_b32 v10, 0x10000, v10
s_cmp_lg_u32 s72, 1
s_cbranch_scc1 L_M1
s_mov_b64 exec, 1
buffer_atomic_add v13, v14, s[56:59], 0 offen sc1
s_mov_b64 exec, -1
L_M1:
s_mov_b32 s78, 0xf0f0f0f0
s_mov_b32 s79, 0xf0f0f0f0
v_cndmask_b32 v80, v88, 0, s[78:79]
v_cndmask_b32 v84, 0, v88, s[78:79]
v_cndmask_b32 v81, v89, 0, s[78:79]
v_cndmask_b32 v85, 0, v89, s[78:79]
v_cndmask_b32 v82, v90, 0, s[78:79]
v_cndmask_b32 v86, 0, v90, s[78:79]
v_cndmask_b32 v83, v91, 0, s[78:79]
v_cndmask_b32 v87, 0, v91, s[78:79]
s_waitcnt vmcnt(8) lgkmcnt(0)
s_barrier
ds_read_b128 v[160:163], v6 offset:0
ds_read_b64_tr_b16 v[48:49], v10 offset:1024
ds_read_b64_tr_b16 v[50:51], v10 offset:1536
ds_read_b64_tr_b16 v[52:53], v10 offset:2048
ds_read_b64_tr_b16 v[54:55], v10 offset:2560
ds_read_b128 v[164:167], v7 offset:0
ds_read_b64_tr_b16 v[56:57], v10 offset:9216
ds_read_b64_tr_b16 v[58:59], v10 offset:9728
ds_read_b64_tr_b16 v[60:61], v10 offset:10240
ds_read_b64_tr_b16 v[62:63], v10 offset:10752
v_mfma_f32_32x32x16_bf16 v[16:31], v[64:67], v[152:155], v[16:31]
s_lshl_b32 s75, s68, 7
s_mul_i32 s74, s68, 0x30000
s_add_u32 m0, s71, 32768
s_add_u32 s68, s68, 1
s_and_b32 s68, s68, 7
buffer_load_dwordx4 v2, s[32:35], s75 offen lds
v_mfma_f32_32x32x16_bf16 v[32:47], v[152:155], v[68:71], v[32:47]
ds_read_b128 v[168:171], v8 offset:0
ds_read_b64_tr_b16 v[64:65], v10 offset:17408
ds_read_b64_tr_b16 v[66:67], v10 offset:17920
ds_read_b64_tr_b16 v[68:69], v10 offset:18432
ds_read_b64_tr_b16 v[70:71], v10 offset:18944
v_mfma_f32_32x32x16_bf16 v[16:31], v[72:75], v[156:159], v[16:31]
buffer_load_dwordx4 v4, s[36:39], s74 offen offset:1024 lds
v_mfma_f32_32x32x16_bf16 v[32:47], v[156:159], v[76:79], v[32:47]
s_waitcnt lgkmcnt(10)
v_mfma_f32_32x32x16_bf16 v[16:31], v[48:51], v[160:163], v[16:31]
ds_read_b128 v[172:175], v9 offset:0
ds_read_b64_tr_b16 v[72:73], v10 offset:25600
ds_read_b64_tr_b16 v[74:75], v10 offset:26112
ds_read_b64_tr_b16 v[76:77], v10 offset:26624
ds_read_b64_tr_b16 v[78:79], v10 offset:27136
buffer_load_dwordx4 v3, s[32:35], s75 offen offset:3072 lds
v_mfma_f32_32x32x16_bf16 v[32:47], v[160:163], v[52:55], v[32:47]
s_waitcnt lgkmcnt(10)
v_mfma_f32_32x32x16_bf16 v[16:31], v[56:59], v[164:167], v[16:31]
buffer_load_dwordx4 v4, s[36:39], s74 offen offset:2048 lds
v_mfma_f32_32x32x16_bf16 v[32:47], v[164:167], v[60:63], v[32:47]
s_cmp_lg_u32 s72, 2
s_cbranch_scc1 L_M2
s_mov_b64 exec, 1
buffer_atomic_add v13, v14, s[56:59], 0 offen sc1
s_mov_b64 exec, -1
L_M2:
s_waitcnt vmcnt(8) lgkmcnt(0)
s_barrier
ds_read_b128 v[176:179], v6 offset:32768
ds_read_b64_tr_b16 v[48:49], v10 offset:33792
ds_read_b64_tr_b16 v[50:51], v10 offset:34304
ds_read_b64_tr_b16 v[52:53], v10 offset:34816
ds_read_b64_tr_b16 v[54:55], v10 offset:35328
ds_read_b128 v[180:183], v7 offset:32768
ds_read_b64_tr_b16 v[56:57], v10 offset:41984
ds_read_b64_tr_b16 v[58:59], v10 offset:42496
ds_read_b64_tr_b16 v[60:61], v10 offset:43008
ds_read_b64_tr_b16 v[62:63], v10 offset:43520
v_mfma_f32_32x32x16_bf16 v[16:31], v[64:67], v[168:171], v[16:31]
s_lshl_b32 s75, s68, 7
s_mul_i32 s74, s68, 0x30000
s_add_u32 m0, s71, 65536
s_add_u32 s68, s68, 1
s_and_b32 s68, s68, 7
buffer_load_dwordx4 v2, s[32:35], s75 offen lds
v_mfma_f32_32x32x16_bf16 v[32:47], v[168:171], v[68:71], v[32:47]
ds_read_b128 v[184:187], v8 offset:32768
ds_read_b64_tr_b16 v[64:65], v10 offset:50176
ds_read_b64_tr_b16 v[66:67], v10 offset:50688
ds_read_b64_tr_b16 v[68:69], v10 offset:51200
ds_read_b64_tr_b16 v[70:71], v10 offset:51712
v_mfma_f32_32x32x16_bf16 v[16:31], v[72:75], v[172:175], v[16:31]
buffer_load_dwordx4 v4, s[36:39], s74 offen offset:1024 lds
v_mfma_f32_32x32x16_bf16 v[32:47], v[172:175], v[76:79], v[32:47]
s_waitcnt lgkmcnt(10)
v_mfma_f32_32x32x16_bf16 v[16:31], v[48:51], v[176:179], v[16:31]
ds_read_b128 v[188:191], v9 offset:32768
ds_read_b64_tr_b16 v[72:73], v10 offset:58368
ds_read_b64_tr_b16 v[74:75], v10 offset:58880
ds_read_b64_tr_b16 v[76:77], v10 offset:59392
ds_read_b64_tr_b16 v[78:79], v10 offset:59904
buffer_load_dwordx4 v3, s[32:35], s75 offen offset:3072 lds
v_mfma_f32_32x32x16_bf16 v[32:47], v[176:179], v[52:55], v[32:47]
s_waitcnt lgkmcnt(10)
v_mfma_f32_32x32x16_bf16 v[16:31], v[56:59], v[180:183], v[16:31]
buffer_load_dwordx4 v4, s[36:39], s74 offen offset:2048 lds
v_mfma_f32_32x32x16_bf16 v[32:47], v[180:183], v[60:63], v[32:47]
v_xor_b32 v6, 0x10000, v6
v_xor_b32 v7, 0x10000, v7
v_xor_b32 v8, 0x10000, v8
v_xor_b32 v9, 0x10000, v9
v_xor_b32 v10, 0x10000, v10
s_cmp_lg_u32 s72, 3
s_cbranch_scc1 L_M3
s_mov_b64 exec, 1
buffer_atomic_add v13, v14, s[56:59], 0 offen sc1
s_mov_b64 exec, -1
L_M3:
s_waitcnt vmcnt(8) lgkmcnt(0)
s_barrier
ds_read_b128 v[192:195], v6 offset:0
ds_read_b64_tr_b16 v[48:49], v10 offset:1024
ds_read_b64_tr_b16 v[50:51], v10 offset:1536
ds_read_b64_tr_b16 v[52:53], v10 offset:2048
ds_read_b64_tr_b16 v[54:55], v10 offset:2560
ds_read_b128 v[196:199], v7 offset:0
ds_read_b64_tr_b16 v[56:57], v10 offset:9216
ds_read_b64_tr_b16 v[58:59], v10 offset:9728
ds_read_b64_tr_b16 v[60:61], v10 offset:10240
ds_read_b64_tr_b16 v[62:63], v10 offset:10752
v_mfma_f32_32x32x16_bf16 v[16:31], v[64:67], v[184:187], v[16:31]
s_lshl_b32 s75, s68, 7
s_mul_i32 s74, s68, 0x30000
s_add_u32 m0, s71, 98304
s_add_u32 s68, s68, 1
s_and_b32 s68, s68, 7
buffer_load_dwordx4 v2, s[32:35], s75 offen lds
v_mfma_f32_32x32x16_bf16 v[32:47], v[184:187], v[68:71], v[32:47]
ds_read_b128 v[200:203], v8 offset:0
ds_read_b64_tr_b16 v[64:65], v10 offset:17408
ds_read_b64_tr_b16 v[66:67], v10 offset:17920
ds_read_b64_tr_b16 v[68:69], v10 offset:18432
ds_read_b64_tr_b16 v[70:71], v10 offset:18944
v_mfma_f32_32x32x16_bf16 v[16:31], v[72:75], v[188:191], v[16:31]
buffer_load_dwordx4 v4, s[36:39], s74 offen offset:1024 lds
v_mfma_f32_32x32x16_bf16 v[32:47], v[188:191], v[76:79], v[32:47]
s_waitcnt lgkmcnt(10)
v_mfma_f32_32x32x16_bf16 v[16:31], v[48:51], v[192:195], v[16:31]
ds_read_b128 v[204:207], v9 offset:0
ds_read_b64_tr_b16 v[72:73], v10 offset:25600
ds_read_b64_tr_b16 v[74:75], v10 offset:26112
ds_read_b64_tr_b16 v[76:77], v10 offset:26624
ds_read_b64_tr_b16 v[78:79], v10 offset:27136
buffer_load_dwordx4 v3, s[32:35], s75 offen offset:3072 lds
v_mfma_f32_32x32x16_bf16 v[32:47], v[192:195], v[52:55], v[32:47]
s_waitcnt lgkmcnt(10)
v_mfma_f32_32x32x16_bf16 v[16:31], v[56:59], v[196:199], v[16:31]
buffer_load_dwordx4 v4, s[36:39], s74 offen offset:2048 lds
v_mfma_f32_32x32x16_bf16 v[32:47], v[196:199], v[60:63], v[32:47]
s_waitcnt vmcnt(8) lgkmcnt(0)
s_barrier
ds_read_b128 v[208:211], v6 offset:32768
ds_read_b64_tr_b16 v[48:49], v10 offset:33792
ds_read_b64_tr_b16 v[50:51], v10 offset:34304
ds_read_b64_tr_b16 v[52:53], v10 offset:34816
ds_read_b64_tr_b16 v[54:55], v10 offset:35328
ds_read_b128 v[212:215], v7 offset:32768
ds_read_b64_tr_b16 v[56:57], v10 offset:41984
ds_read_b64_tr_b16 v[58:59], v10 offset:42496
ds_read_b64_tr_b16 v[60:61], v10 offset:43008
ds_read_b64_tr_b16 v[62:63], v10 offset:43520
v_mfma_f32_32x32x16_bf16 v[16:31], v[64:67], v[200:203], v[16:31]
s_mul_i32 s74, s68, 0x30000
s_add_u32 m0, s71, 0
s_add_u32 s68, s68, 1
s_and_b32 s68, s68, 7
buffer_load_dwordx4 v4, s[36:39], s74 offen lds
v_mfma_f32_32x32x16_bf16 v[32:47], v[200:203], v[68:71], v[32:47]
ds_read_b128 v[216:219], v8 offset:32768
ds_read_b64_tr_b16 v[64:65], v10 offset:50176
ds_read_b64_tr_b16 v[66:67], v10 offset:50688
ds_read_b64_tr_b16 v[68:69], v10 offset:51200
ds_read_b64_tr_b16 v[70:71], v10 offset:51712
v_mfma_f32_32x32x16_bf16 v[16:31], v[72:75], v[204:207], v[16:31]
s_mul_i32 s74, s68, 0x30000
s_add_u32 m0, s71, 1024
s_add_u32 s68, s68, 1
s_and_b32 s68, s68, 7
buffer_load_dwordx4 v4, s[36:39], s74 offen lds
v_mfma_f32_32x32x16_bf16 v[32:47], v[204:207], v[76:79], v[32:47]
s_waitcnt lgkmcnt(10)
v_mfma_f32_32x32x16_bf16 v[16:31], v[48:51], v[208:211], v[16:31]
ds_read_b128 v[220:223], v9 offset:32768
ds_read_b64_tr_b16 v[72:73], v10 offset:58368
ds_read_b64_tr_b16 v[74:75], v10 offset:58880
ds_read_b64_tr_b16 v[76:77], v10 offset:59392
ds_read_b64_tr_b16 v[78:79], v10 offset:59904
s_mul_i32 s74, s68, 0x30000
s_add_u32 m0, s71, 2048
s_add_u32 s68, s68, 1
s_and_b32 s68, s68, 7
buffer_load_dwordx4 v4, s[36:39], s74 offen lds
v_mfma_f32_32x32x16_bf16 v[32:47], v[208:211], v[52:55], v[32:47]
s_waitcnt lgkmcnt(10)
v_mfma_f32_32x32x16_bf16 v[16:31], v[56:59], v[212:215], v[16:31]
s_mul_i32 s74, s68, 0x30000
s_add_u32 m0, s71, 3072
s_add_u32 s68, s68, 1
s_and_b32 s68, s68, 7
buffer_load_dwordx4 v4, s[36:39], s74 offen lds
v_mfma_f32_32x32x16_bf16 v[32:47], v[212:215], v[60:63], v[32:47]
v_xor_b32 v6, 0x10000, v6
v_xor_b32 v7, 0x10000, v7
v_xor_b32 v8, 0x10000, v8
v_xor_b32 v9, 0x10000, v9
v_xor_b32 v10, 0x10000, v10
s_waitcnt vmcnt(8) lgkmcnt(0)
s_barrier
ds_read_b128 v[224:227], v6 offset:0
ds_read_b64_tr_b16 v[48:49], v10 offset:1024
ds_read_b64_tr_b16 v[50:51], v10 offset:1536
ds_read_b64_tr_b16 v[52:53], v10 offset:2048
ds_read_b64_tr_b16 v[54:55], v10 offset:2560
ds_read_b128 v[228:231], v7 offset:0
ds_read_b64_tr_b16 v[56:57], v10 offset:9216
ds_read_b64_tr_b16 v[58:59], v10 offset:9728
ds_read_b64_tr_b16 v[60:61], v10 offset:10240
ds_read_b64_tr_b16 v[62:63], v10 offset:10752
v_mfma_f32_32x32x16_bf16 v[16:31], v[64:67], v[216:219], v[16:31]
s_mul_i32 s74, s68, 0x30000
s_add_u32 m0, s71, 32768
s_add_u32 s68, s68, 1
s_and_b32 s68, s68, 7
buffer_load_dwordx4 v4, s[36:39], s74 offen lds
v_mfma_f32_32x32x16_bf16 v[32:47], v[216:219], v[68:71], v[32:47]
ds_read_b128 v[232:235], v8 offset:0
ds_read_b64_tr_b16 v[64:65], v10 offset:17408
ds_read_b64_tr_b16 v[66:67], v10 offset:17920
ds_read_b64_tr_b16 v[68:69], v10 offset:18432
ds_read_b64_tr_b16 v[70:71], v10 offset:18944
v_mfma_f32_32x32x16_bf16 v[16:31], v[72:75], v[220:223], v[16:31]
s_mul_i32 s74, s68, 0x30000
s_add_u32 m0, s71, 33792
s_add_u32 s68, s68, 1
s_and_b32 s68, s68, 7
buffer_load_dwordx4 v4, s[36:39], s74 offen lds
v_mfma_f32_32x32x16_bf16 v[32:47], v[220:223], v[76:79], v[32:47]
s_waitcnt lgkmcnt(10)
v_mfma_f32_32x32x16_bf16 v[16:31], v[48:51], v[224:227], v[16:31]
ds_read_b128 v[236:239], v9 offset:0
ds_read_b64_tr_b16 v[72:73], v10 offset:25600
ds_read_b64_tr_b16 v[74:75], v10 offset:26112
ds_read_b64_tr_b16 v[76:77], v10 offset:26624
ds_read_b64_tr_b16 v[78:79], v10 offset:27136
s_mul_i32 s74, s68, 0x30000
s_add_u32 m0, s71, 34816
s_add_u32 s68, s68, 1
s_and_b32 s68, s68, 7
buffer_load_dwordx4 v4, s[36:39], s74 offen lds
v_mfma_f32_32x32x16_bf16 v[32:47], v[224:227], v[52:55], v[32:47]
s_waitcnt lgkmcnt(10)
v_mfma_f32_32x32x16_bf16 v[16:31], v[56:59], v[228:231], v[16:31]
s_mul_i32 s74, s68, 0x30000
s_add_u32 m0, s71, 35840
s_add_u32 s68, s68, 1
s_and_b32 s68, s68, 7
buffer_load_dwordx4 v4, s[36:39], s74 offen lds
v_mfma_f32_32x32x16_bf16 v[32:47], v[228:231], v[60:63], v[32:47]
s_waitcnt vmcnt(8) lgkmcnt(0)
s_barrier
ds_read_b128 v[240:243], v6 offset:32768
ds_read_b64_tr_b16 v[48:49], v10 offset:33792
ds_read_b64_tr_b16 v[50:51], v10 offset:34304
ds_read_b64_tr_b16 v[52:53], v10 offset:34816
ds_read_b64_tr_b16 v[54:55], v10 offset:35328
ds_read_b128 v[244:247], v7 offset:32768
ds_read_b64_tr_b16 v[56:57], v10 offset:41984
ds_read_b64_tr_b16 v[58:59], v10 offset:42496
ds_read_b64_tr_b16 v[60:61], v10 offset:43008
ds_read_b64_tr_b16 v[62:63], v10 offset:43520
v_mfma_f32_32x32x16_bf16 v[16:31], v[64:67], v[232:235], v[16:31]
v_mfma_f32_32x32x16_bf16 v[32:47], v[232:235], v[68:71], v[32:47]
ds_read_b128 v[248:251], v8 offset:32768
ds_read_b64_tr_b16 v[64:65], v10 offset:50176
ds_read_b64_tr_b16 v[66:67], v10 offset:50688
ds_read_b64_tr_b16 v[68:69], v10 offset:51200
ds_read_b64_tr_b16 v[70:71], v10 offset:51712
v_mfma_f32_32x32x16_bf16 v[16:31], v[72:75], v[236:239], v[16:31]
v_mfma_f32_32x32x16_bf16 v[32:47], v[236:239], v[76:79], v[32:47]
s_waitcnt lgkmcnt(10)
v_mfma_f32_32x32x16_bf16 v[16:31], v[48:51], v[240:243], v[16:31]
ds_read_b128 v[252:255], v9 offset:32768
ds_read_b64_tr_b16 v[72:73], v10 offset:58368
ds_read_b64_tr_b16 v[74:75], v10 offset:58880
ds_read_b64_tr_b16 v[76:77], v10 offset:59392
ds_read_b64_tr_b16 v[78:79], v10 offset:59904
v_mfma_f32_32x32x16_bf16 v[32:47], v[240:243], v[52:55], v[32:47]
s_waitcnt lgkmcnt(10)
v_mfma_f32_32x32x16_bf16 v[16:31], v[56:59], v[244:247], v[16:31]
v_mfma_f32_32x32x16_bf16 v[32:47], v[244:247], v[60:63], v[32:47]
v_xor_b32 v6, 0x10000, v6
v_xor_b32 v7, 0x10000, v7
v_xor_b32 v8, 0x10000, v8
v_xor_b32 v9, 0x10000, v9
v_xor_b32 v10, 0x10000, v10
s_waitcnt lgkmcnt(5)
v_mfma_f32_32x32x16_bf16 v[16:31], v[64:67], v[248:251], v[16:31]
s_waitcnt lgkmcnt(0)
v_mfma_f32_32x32x16_bf16 v[16:31], v[72:75], v[252:255], v[16:31]
v_mfma_f32_32x32x16_bf16 v[32:47], v[248:251], v[68:71], v[32:47]
v_mfma_f32_32x32x16_bf16 v[32:47], v[252:255], v[76:79], v[32:47]
s_nop 9
v_cvt_pk_bf16_f32 v88, v16, v17
v_cvt_pk_bf16_f32 v89, v18, v19
v_cvt_pk_bf16_f32 v90, v20, v21
v_cvt_pk_bf16_f32 v91, v22, v23
v_cvt_pk_bf16_f32 v92, v24, v25
v_cvt_pk_bf16_f32 v93, v26, v27
v_cvt_pk_bf16_f32 v94, v28, v29
v_cvt_pk_bf16_f32 v95, v30, v31
v_mfma_f32_32x32x16_bf16 v[48:63], v[80:83], v[88:91], 0
s_nop 0
v_mfma_f32_32x32x16_bf16 v[48:63], v[84:87], v[92:95], v[48:63]
v_cvt_pk_bf16_f32 v16, v32, v33
v_cvt_pk_bf16_f32 v17, v34, v35
v_cvt_pk_bf16_f32 v18, v36, v37
v_cvt_pk_bf16_f32 v19, v38, v39
v_cvt_pk_bf16_f32 v20, v40, v41
v_cvt_pk_bf16_f32 v21, v42, v43
v_cvt_pk_bf16_f32 v22, v44, v45
v_cvt_pk_bf16_f32 v23, v46, v47
ds_write_b128 v104, v[16:19]
ds_write_b128 v104, v[20:23] offset:1024
s_nop 1
v_max3_f32 v120, v48, v49, v50
v_max3_f32 v121, v51, v52, v53
v_min3_f32 v122, v48, v49, v50
v_min3_f32 v123, v51, v52, v53
v_max3_f32 v120, v120, v54, v55
v_max3_f32 v121, v121, v56, v57
v_min3_f32 v122, v122, v54, v55
v_min3_f32 v123, v123, v56, v57
v_max3_f32 v120, v120, v58, v59
v_max3_f32 v121, v121, v60, v61
v_min3_f32 v122, v122, v58, v59
v_min3_f32 v123, v123, v60, v61
v_max3_f32 v120, v120, v62, v63
v_min3_f32 v122, v122, v62, v63
v_max_f32 v120, v120, v121
v_min_f32 v122, v122, v123
v_mul_f32 v120, s76, v120
v_mul_f32 v122, s76, v122
v_pk_fma_f32 v[64:65], v[48:49], s[76:77], v[120:121] op_sel_hi:[1,0,0] neg_lo:[0,0,1] neg_hi:[0,0,1]
v_pk_fma_f32 v[88:89], v[48:49], s[76:77], v[122:123] op_sel_hi:[1,0,0] neg_lo:[1,0,0] neg_hi:[1,0,0]
v_pk_fma_f32 v[66:67], v[50:51], s[76:77], v[120:121] op_sel_hi:[1,0,0] neg_lo:[0,0,1] neg_hi:[0,0,1]
v_pk_fma_f32 v[90:91], v[50:51], s[76:77], v[122:123] op_sel_hi:[1,0,0] neg_lo:[1,0,0] neg_hi:[1,0,0]
v_exp_f32 v64, v64
v_exp_f32 v88, v88
v_exp_f32 v65, v65
v_exp_f32 v89, v89
v_pk_fma_f32 v[68:69], v[52:53], s[76:77], v[120:121] op_sel_hi:[1,0,0] neg_lo:[0,0,1] neg_hi:[0,0,1]
v_pk_fma_f32 v[92:93], v[52:53], s[76:77], v[122:123] op_sel_hi:[1,0,0] neg_lo:[1,0,0] neg_hi:[1,0,0]
v_exp_f32 v66, v66
v_exp_f32 v90, v90
v_exp_f32 v67, v67
v_exp_f32 v91, v91
v_pk_fma_f32 v[70:71], v[54:55], s[76:77], v[120:121] op_sel_hi:[1,0,0] neg_lo:[0,0,1] neg_hi:[0,0,1]
v_pk_fma_f32 v[94:95], v[54:55], s[76:77], v[122:123] op_sel_hi:[1,0,0] neg_lo:[1,0,0] neg_hi:[1,0,0]
v_exp_f32 v68, v68
v_exp_f32 v92, v92
v_exp_f32 v69, v69
v_exp_f32 v93, v93
v_pk_add_f32 v[6:7], v[64:65], v[66:67]
v_pk_add_f32 v[8:9], v[88:89], v[90:91]
v_pk_fma_f32 v[72:73], v[56:57], s[76:77], v[120:121] op_sel_hi:[1,0,0] neg_lo:[0,0,1] neg_hi:[0,0,1]
v_pk_fma_f32 v[96:97], v[56:57], s[76:77], v[122:123] op_sel_hi:[1,0,0] neg_lo:[1,0,0] neg_hi:[1,0,0]
v_exp_f32 v70, v70
v_exp_f32 v94, v94
v_exp_f32 v71, v71
v_exp_f32 v95, v95
v_pk_add_f32 v[6:7], v[6:7], v[68:69]
v_pk_add_f32 v[8:9], v[8:9], v[92:93]
v_pk_fma_f32 v[74:75], v[58:59], s[76:77], v[120:121] op_sel_hi:[1,0,0] neg_lo:[0,0,1] neg_hi:[0,0,1]
v_pk_fma_f32 v[98:99], v[58:59], s[76:77], v[122:123] op_sel_hi:[1,0,0] neg_lo:[1,0,0] neg_hi:[1,0,0]
v_exp_f32 v72, v72
v_exp_f32 v96, v96
v_exp_f32 v73, v73
v_exp_f32 v97, v97
v_pk_add_f32 v[6:7], v[6:7], v[70:71]
v_pk_add_f32 v[8:9], v[8:9], v[94:95]
v_pk_fma_f32 v[76:77], v[60:61], s[76:77], v[120:121] op_sel_hi:[1,0,0] neg_lo:[0,0,1] neg_hi:[0,0,1]
v_pk_fma_f32 v[100:101], v[60:61], s[76:77], v[122:123] op_sel_hi:[1,0,0] neg_lo:[1,0,0] neg_hi:[1,0,0]
v_exp_f32 v74, v74
v_exp_f32 v98, v98
v_exp_f32 v75, v75
v_exp_f32 v99, v99
v_pk_add_f32 v[6:7], v[6:7], v[72:73]
v_pk_add_f32 v[8:9], v[8:9], v[96:97]
v_pk_fma_f32 v[78:79], v[62:63], s[76:77], v[120:121] op_sel_hi:[1,0,0] neg_lo:[0,0,1] neg_hi:[0,0,1]
v_pk_fma_f32 v[102:103], v[62:63], s[76:77], v[122:123] op_sel_hi:[1,0,0] neg_lo:[1,0,0] neg_hi:[1,0,0]
v_exp_f32 v76, v76
v_exp_f32 v100, v100
v_exp_f32 v77, v77
v_exp_f32 v101, v101
v_pk_add_f32 v[6:7], v[6:7], v[74:75]
v_pk_add_f32 v[8:9], v[8:9], v[98:99]
v_exp_f32 v78, v78
v_exp_f32 v102, v102
v_exp_f32 v79, v79
v_exp_f32 v103, v103
v_pk_add_f32 v[6:7], v[6:7], v[76:77]
v_pk_add_f32 v[8:9], v[8:9], v[100:101]
v_pk_add_f32 v[6:7], v[6:7], v[78:79]
v_pk_add_f32 v[8:9], v[8:9], v[102:103]
s_cmp_lg_u32 s70, 0
s_cbranch_scc1 L_A2
buffer_load_dword v15, v14, s[56:59], 0 offen sc1
L_A2:
v_add_f32 v123, v8, v9
v_add_f32 v121, v6, v7
v_rcp_f32 v120, v121
v_rcp_f32 v122, v123
v_pk_mul_f32 v[64:65], v[64:65], v[120:121] op_sel_hi:[1,0]
v_cvt_pk_bf16_f32 v48, v64, v65
v_pk_mul_f32 v[66:67], v[66:67], v[120:121] op_sel_hi:[1,0]
v_cvt_pk_bf16_f32 v49, v66, v67
v_pk_mul_f32 v[68:69], v[68:69], v[120:121] op_sel_hi:[1,0]
v_cvt_pk_bf16_f32 v50, v68, v69
v_pk_mul_f32 v[70:71], v[70:71], v[120:121] op_sel_hi:[1,0]
v_cvt_pk_bf16_f32 v51, v70, v71
ds_write_b128 v105, v[48:51]
v_pk_mul_f32 v[72:73], v[72:73], v[120:121] op_sel_hi:[1,0]
v_cvt_pk_bf16_f32 v52, v72, v73
v_pk_mul_f32 v[74:75], v[74:75], v[120:121] op_sel_hi:[1,0]
v_cvt_pk_bf16_f32 v53, v74, v75
v_pk_mul_f32 v[76:77], v[76:77], v[120:121] op_sel_hi:[1,0]
v_cvt_pk_bf16_f32 v54, v76, v77
v_pk_mul_f32 v[78:79], v[78:79], v[120:121] op_sel_hi:[1,0]
v_cvt_pk_bf16_f32 v55, v78, v79
ds_write_b128 v106, v[52:55]
v_pk_mul_f32 v[88:89], v[88:89], v[122:123] op_sel_hi:[1,0]
v_cvt_pk_bf16_f32 v56, v88, v89
v_pk_mul_f32 v[90:91], v[90:91], v[122:123] op_sel_hi:[1,0]
v_cvt_pk_bf16_f32 v57, v90, v91
v_pk_mul_f32 v[92:93], v[92:93], v[122:123] op_sel_hi:[1,0]
v_cvt_pk_bf16_f32 v58, v92, v93
v_pk_mul_f32 v[94:95], v[94:95], v[122:123] op_sel_hi:[1,0]
v_cvt_pk_bf16_f32 v59, v94, v95
ds_write_b128 v107, v[56:59]
v_pk_mul_f32 v[96:97], v[96:97], v[122:123] op_sel_hi:[1,0]
v_cvt_pk_bf16_f32 v60, v96, v97
v_pk_mul_f32 v[98:99], v[98:99], v[122:123] op_sel_hi:[1,0]
v_cvt_pk_bf16_f32 v61, v98, v99
v_pk_mul_f32 v[100:101], v[100:101], v[122:123] op_sel_hi:[1,0]
v_cvt_pk_bf16_f32 v62, v100, v101
v_pk_mul_f32 v[102:103], v[102:103], v[122:123] op_sel_hi:[1,0]
v_cvt_pk_bf16_f32 v63, v102, v103
ds_write_b128 v108, v[60:63]
v_mov_b32 v120, 0x3f803f80
v_mov_b32 v121, 0x3f803f80
v_mov_b32 v122, 0x3f803f80
v_mov_b32 v123, 0x3f803f80
s_waitcnt lgkmcnt(0)
s_barrier
ds_read_b64_tr_b16 v[64:65], v109 offset:0
ds_read_b64_tr_b16 v[66:67], v109 offset:512
ds_read_b128 v[68:71], v110 offset:0
ds_read_b64_tr_b16 v[72:73], v109 offset:2048
ds_read_b64_tr_b16 v[74:75], v109 offset:2560
ds_read_b128 v[76:79], v110 offset:4096
ds_read_b64_tr_b16 v[88:89], v109 offset:4096
ds_read_b64_tr_b16 v[90:91], v109 offset:4608
ds_read_b128 v[92:95], v110 offset:8192
ds_read_b64_tr_b16 v[96:97], v109 offset:6144
ds_read_b64_tr_b16 v[98:99], v109 offset:6656
ds_read_b128 v[100:103], v110 offset:12288
s_waitcnt lgkmcnt(9)
v_mfma_f32_16x16x32_bf16 v[48:51], v[64:67], v[68:71], 0
v_mfma_f32_16x16x32_bf16 v[52:55], v[64:67], v[120:123], 0
s_waitcnt lgkmcnt(6)
v_mfma_f32_16x16x32_bf16 v[48:51], v[72:75], v[76:79], v[48:51]
v_mfma_f32_16x16x32_bf16 v[52:55], v[72:75], v[120:123], v[52:55]
s_waitcnt lgkmcnt(3)
v_mfma_f32_16x16x32_bf16 v[48:51], v[88:91], v[92:95], v[48:51]
v_mfma_f32_16x16x32_bf16 v[52:55], v[88:91], v[120:123], v[52:55]
s_waitcnt lgkmcnt(0)
v_mfma_f32_16x16x32_bf16 v[48:51], v[96:99], v[100:103], v[48:51]
v_mfma_f32_16x16x32_bf16 v[52:55], v[96:99], v[120:123], v[52:55]
s_nop 6
v_cvt_pk_bf16_f32 v48, v48, v49
v_cvt_pk_bf16_f32 v49, v50, v51
v_cvt_pk_bf16_f32 v52, v52, v53
v_cvt_pk_bf16_f32 v53, v54, v55
buffer_store_dwordx2 v[48:49], v111, s[48:51], s61 offen sc1
s_mov_b32 exec_lo, 0x10001
s_mov_b32 exec_hi, 0x10001
buffer_store_dwordx2 v[52:53], v112, s[48:51], s62 offen sc1
s_mov_b64 exec, -1
s_waitcnt vmcnt(2)
s_cmp_lg_u32 s70, 0
s_cbranch_scc1 L_G1_y
s_mov_b32 s3, 0x100000
s_waitcnt vmcnt(2)
L_G1:
v_cmp_gt_u32 vcc, 64, v15
s_cbranch_vccz L_G1_y
buffer_load_dword v15, v14, s[56:59], 0 offen sc1
s_sub_u32 s3, s3, 1
s_waitcnt vmcnt(0)
s_cbranch_scc0 L_G1
L_G1_y:
s_cmp_lt_u32 s70, 4
s_barrier
s_cbranch_scc1 L_A3
s_add_u32 m0, s69, 98304
s_xor_b32 s3, s63, 0
buffer_load_dwordx4 v113, s[44:47], s3 offen offset:0 lds
s_xor_b32 s3, s63, 3072
buffer_load_dwordx4 v113, s[44:47], s3 offen offset:1024 lds
s_xor_b32 s3, s63, 6144
buffer_load_dwordx4 v113, s[44:47], s3 offen offset:2048 lds
s_xor_b32 s3, s63, 9216
buffer_load_dwordx4 v113, s[44:47], s3 offen offset:3072 lds
s_add_u32 m0, s69, 114688
s_xor_b32 s3, s63, 65536
buffer_load_dwordx4 v113, s[44:47], s3 offen offset:0 lds
s_xor_b32 s3, s63, 68608
buffer_load_dwordx4 v113, s[44:47], s3 offen offset:1024 lds
s_xor_b32 s3, s63, 71680
buffer_load_dwordx4 v113, s[44:47], s3 offen offset:2048 lds
s_xor_b32 s3, s63, 74752
buffer_load_dwordx4 v113, s[44:47], s3 offen offset:3072 lds
s_add_u32 m0, s69, 65536
s_xor_b32 s3, s63, 131072
buffer_load_dwordx4 v113, s[44:47], s3 offen offset:0 lds
s_xor_b32 s3, s63, 134144
buffer_load_dwordx4 v113, s[44:47], s3 offen offset:1024 lds
s_xor_b32 s3, s63, 137216
buffer_load_dwordx4 v113, s[44:47], s3 offen offset:2048 lds
s_xor_b32 s3, s63, 140288
buffer_load_dwordx4 v113, s[44:47], s3 offen offset:3072 lds
s_add_u32 m0, s69, 81920
s_xor_b32 s3, s63, 196608
buffer_load_dwordx4 v113, s[44:47], s3 offen offset:0 lds
s_xor_b32 s3, s63, 199680
buffer_load_dwordx4 v113, s[44:47], s3 offen offset:1024 lds
s_xor_b32 s3, s63, 202752
buffer_load_dwordx4 v113, s[44:47], s3 offen offset:2048 lds
s_xor_b32 s3, s63, 205824
buffer_load_dwordx4 v113, s[44:47], s3 offen offset:3072 lds
L_A3:
ds_read_b64_tr_b16 v[32:33], v10 offset:0
ds_read_b64_tr_b16 v[34:35], v10 offset:512
ds_read_b64_tr_b16 v[36:37], v10 offset:8192
ds_read_b64_tr_b16 v[38:39], v10 offset:8704
ds_read_b64_tr_b16 v[40:41], v10 offset:16384
ds_read_b64_tr_b16 v[42:43], v10 offset:16896
ds_read_b64_tr_b16 v[44:45], v10 offset:24576
ds_read_b64_tr_b16 v[46:47], v10 offset:25088
s_waitcnt lgkmcnt(6)
v_mfma_f32_32x32x16_bf16 v[16:31], v[32:35], v[128:131], 0
ds_read_b64_tr_b16 v[32:33], v10 offset:1024
ds_read_b64_tr_b16 v[34:35], v10 offset:1536
s_waitcnt lgkmcnt(6)
v_mfma_f32_32x32x16_bf16 v[16:31], v[36:39], v[132:135], v[16:31]
ds_read_b64_tr_b16 v[36:37], v10 offset:9216
ds_read_b64_tr_b16 v[38:39], v10 offset:9728
s_waitcnt lgkmcnt(6)
v_mfma_f32_32x32x16_bf16 v[16:31], v[40:43], v[136:139], v[16:31]
ds_read_b64_tr_b16 v[40:41], v10 offset:17408
ds_read_b64_tr_b16 v[42:43], v10 offset:17920
s_waitcnt lgkmcnt(6)
v_mfma_f32_32x32x16_bf16 v[16:31], v[44:47], v[140:143], v[16:31]
ds_read_b64_tr_b16 v[44:45], v10 offset:25600
ds_read_b64_tr_b16 v[46:47], v10 offset:26112
s_waitcnt lgkmcnt(6)
v_mfma_f32_32x32x16_bf16 v[16:31], v[32:35], v[144:147], v[16:31]
ds_read_b64_tr_b16 v[32:33], v10 offset:2048
ds_read_b64_tr_b16 v[34:35], v10 offset:2560
s_waitcnt lgkmcnt(6)
v_mfma_f32_32x32x16_bf16 v[16:31], v[36:39], v[148:151], v[16:31]
ds_read_b64_tr_b16 v[36:37], v10 offset:10240
ds_read_b64_tr_b16 v[38:39], v10 offset:10752
s_waitcnt lgkmcnt(6)
v_mfma_f32_32x32x16_bf16 v[16:31], v[40:43], v[152:155], v[16:31]
ds_read_b64_tr_b16 v[40:41], v10 offset:18432
ds_read_b64_tr_b16 v[42:43], v10 offset:18944
s_waitcnt lgkmcnt(6)
v_mfma_f32_32x32x16_bf16 v[16:31], v[44:47], v[156:159], v[16:31]
ds_read_b64_tr_b16 v[44:45], v10 offset:26624
ds_read_b64_tr_b16 v[46:47], v10 offset:27136
s_waitcnt lgkmcnt(6)
v_mfma_f32_32x32x16_bf16 v[16:31], v[32:35], v[160:163], v[16:31]
ds_read_b64_tr_b16 v[32:33], v10 offset:3072
ds_read_b64_tr_b16 v[34:35], v10 offset:3584
s_waitcnt lgkmcnt(6)
v_mfma_f32_32x32x16_bf16 v[16:31], v[36:39], v[164:167], v[16:31]
ds_read_b64_tr_b16 v[36:37], v10 offset:11264
ds_read_b64_tr_b16 v[38:39], v10 offset:11776
s_waitcnt lgkmcnt(6)
v_mfma_f32_32x32x16_bf16 v[16:31], v[40:43], v[168:171], v[16:31]
ds_read_b64_tr_b16 v[40:41], v10 offset:19456
ds_read_b64_tr_b16 v[42:43], v10 offset:19968
s_waitcnt lgkmcnt(6)
v_mfma_f32_32x32x16_bf16 v[16:31], v[44:47], v[172:175], v[16:31]
ds_read_b64_tr_b16 v[44:45], v10 offset:27648
ds_read_b64_tr_b16 v[46:47], v10 offset:28160
s_waitcnt lgkmcnt(6)
v_mfma_f32_32x32x16_bf16 v[16:31], v[32:35], v[176:179], v[16:31]
ds_read_b64_tr_b16 v[32:33], v10 offset:32768
ds_read_b64_tr_b16 v[34:35], v10 offset:33280
s_waitcnt lgkmcnt(6)
v_mfma_f32_32x32x16_bf16 v[16:31], v[36:39], v[180:183], v[16:31]
ds_read_b64_tr_b16 v[36:37], v10 offset:40960
ds_read_b64_tr_b16 v[38:39], v10 offset:41472
s_waitcnt lgkmcnt(6)
v_mfma_f32_32x32x16_bf16 v[16:31], v[40:43], v[184:187], v[16:31]
ds_read_b64_tr_b16 v[40:41], v10 offset:49152
ds_read_b64_tr_b16 v[42:43], v10 offset:49664
s_waitcnt lgkmcnt(6)
v_mfma_f32_32x32x16_bf16 v[16:31], v[44:47], v[188:191], v[16:31]
ds_read_b64_tr_b16 v[44:45], v10 offset:57344
ds_read_b64_tr_b16 v[46:47], v10 offset:57856
s_waitcnt lgkmcnt(6)
v_mfma_f32_32x32x16_bf16 v[16:31], v[32:35], v[192:195], v[16:31]
ds_read_b64_tr_b16 v[32:33], v10 offset:33792
ds_read_b64_tr_b16 v[34:35], v10 offset:34304
s_waitcnt lgkmcnt(6)
v_mfma_f32_32x32x16_bf16 v[16:31], v[36:39], v[196:199], v[16:31]
ds_read_b64_tr_b16 v[36:37], v10 offset:41984
ds_read_b64_tr_b16 v[38:39], v10 offset:42496
s_waitcnt lgkmcnt(6)
v_mfma_f32_32x32x16_bf16 v[16:31], v[40:43], v[200:203], v[16:31]
ds_read_b64_tr_b16 v[40:41], v10 offset:50176
ds_read_b64_tr_b16 v[42:43], v10 offset:50688
s_waitcnt lgkmcnt(6)
v_mfma_f32_32x32x16_bf16 v[16:31], v[44:47], v[204:207], v[16:31]
ds_read_b64_tr_b16 v[44:45], v10 offset:58368
ds_read_b64_tr_b16 v[46:47], v10 offset:58880
s_waitcnt lgkmcnt(6)
v_mfma_f32_32x32x16_bf16 v[16:31], v[32:35], v[208:211], v[16:31]
ds_read_b64_tr_b16 v[32:33], v10 offset:34816
ds_read_b64_tr_b16 v[34:35], v10 offset:35328
s_waitcnt lgkmcnt(6)
v_mfma_f32_32x32x16_bf16 v[16:31], v[36:39], v[212:215], v[16:31]
ds_read_b64_tr_b16 v[36:37], v10 offset:43008
ds_read_b64_tr_b16 v[38:39], v10 offset:43520
s_waitcnt lgkmcnt(6)
v_mfma_f32_32x32x16_bf16 v[16:31], v[40:43], v[216:219], v[16:31]
ds_read_b64_tr_b16 v[40:41], v10 offset:51200
ds_read_b64_tr_b16 v[42:43], v10 offset:51712
s_waitcnt lgkmcnt(6)
v_mfma_f32_32x32x16_bf16 v[16:31], v[44:47], v[220:223], v[16:31]
ds_read_b64_tr_b16 v[44:45], v10 offset:59392
ds_read_b64_tr_b16 v[46:47], v10 offset:59904
s_waitcnt lgkmcnt(6)
v_mfma_f32_32x32x16_bf16 v[16:31], v[32:35], v[224:227], v[16:31]
ds_read_b64_tr_b16 v[32:33], v10 offset:35840
ds_read_b64_tr_b16 v[34:35], v10 offset:36352
s_waitcnt lgkmcnt(6)
v_mfma_f32_32x32x16_bf16 v[16:31], v[36:39], v[228:231], v[16:31]
ds_read_b64_tr_b16 v[36:37], v10 offset:44032
ds_read_b64_tr_b16 v[38:39], v10 offset:44544
s_waitcnt lgkmcnt(6)
v_mfma_f32_32x32x16_bf16 v[16:31], v[40:43], v[232:235], v[16:31]
ds_read_b64_tr_b16 v[40:41], v10 offset:52224
ds_read_b64_tr_b16 v[42:43], v10 offset:52736
s_waitcnt lgkmcnt(6)
v_mfma_f32_32x32x16_bf16 v[16:31], v[44:47], v[236:239], v[16:31]
ds_read_b64_tr_b16 v[44:45], v10 offset:60416
ds_read_b64_tr_b16 v[46:47], v10 offset:60928
s_waitcnt lgkmcnt(6)
v_mfma_f32_32x32x16_bf16 v[16:31], v[32:35], v[240:243], v[16:31]
s_waitcnt lgkmcnt(4)
v_mfma_f32_32x32x16_bf16 v[16:31], v[36:39], v[244:247], v[16:31]
s_waitcnt lgkmcnt(2)
v_mfma_f32_32x32x16_bf16 v[16:31], v[40:43], v[248:251], v[16:31]
s_waitcnt lgkmcnt(0)
v_mfma_f32_32x32x16_bf16 v[16:31], v[44:47], v[252:255], v[16:31]
s_lshl_b32 s73, s64, 16
s_add_u32 s73, s73, 65536
s_lshl_b32 s74, s64, 12
s_add_u32 s74, s74, 589824
s_cmp_lt_u32 s70, 4
s_nop 6
v_cvt_pk_bf16_f32 v64, v16, v17
v_cvt_pk_bf16_f32 v65, v18, v19
v_cvt_pk_bf16_f32 v66, v20, v21
v_cvt_pk_bf16_f32 v67, v22, v23
v_cvt_pk_bf16_f32 v68, v24, v25
v_cvt_pk_bf16_f32 v69, v26, v27
v_cvt_pk_bf16_f32 v70, v28, v29
v_cvt_pk_bf16_f32 v71, v30, v31
v_mfma_f32_32x32x16_bf16 v[48:63], v[80:83], v[64:67], 0
s_nop 0
v_mfma_f32_32x32x16_bf16 v[48:63], v[84:87], v[68:71], v[48:63]
s_cbranch_scc0 L_A6
v_and_b32 v2, 1, v1
v_lshlrev_b32 v2, 4, v2
v_mov_b32 v4, 0x3f80
v_lshlrev_b32 v2, v2, v4
s_mov_b32 s78, 0x30003
s_mov_b32 s79, s78
v_cndmask_b32 v32, 0, v2, s[78:79]
s_mov_b32 s78, 0xc000c
s_mov_b32 s79, s78
v_cndmask_b32 v33, 0, v2, s[78:79]
s_mov_b32 s78, 0x300030
s_mov_b32 s79, s78
v_cndmask_b32 v34, 0, v2, s[78:79]
s_mov_b32 s78, 0xc000c0
s_mov_b32 s79, s78
v_cndmask_b32 v35, 0, v2, s[78:79]
s_mov_b32 s78, 0x3000300
s_mov_b32 s79, s78
v_cndmask_b32 v36, 0, v2, s[78:79]
s_mov_b32 s78, 0xc000c00
s_mov_b32 s79, s78
v_cndmask_b32 v37, 0, v2, s[78:79]
s_mov_b32 s78, 0x30003000
s_mov_b32 s79, s78
v_cndmask_b32 v38, 0, v2, s[78:79]
s_mov_b32 s78, 0xc000c000
s_mov_b32 s79, s78
v_cndmask_b32 v39, 0, v2, s[78:79]
v_max3_f32 v120, v48, v49, v50
v_max3_f32 v121, v51, v52, v53
v_min3_f32 v122, v48, v49, v50
v_min3_f32 v123, v51, v52, v53
v_max3_f32 v120, v120, v54, v55
v_max3_f32 v121, v121, v56, v57
v_min3_f32 v122, v122, v54, v55
v_min3_f32 v123, v123, v56, v57
v_max3_f32 v120, v120, v58, v59
v_max3_f32 v121, v121, v60, v61
v_min3_f32 v122, v122, v58, v59
v_min3_f32 v123, v123, v60, v61
v_max3_f32 v120, v120, v62, v63
v_min3_f32 v122, v122, v62, v63
v_max_f32 v120, v120, v121
v_min_f32 v122, v122, v123
v_mul_f32 v120, s76, v120
v_mul_f32 v122, s76, v122
buffer_load_dwordx4 v[104:107], v115, s[48:51], s74 offen offset:0
v_fma_f32 v64, v48, s76, -v120
v_fma_f32 v88, -v48, s76, v122
v_fma_f32 v65, v49, s76, -v120
buffer_load_dwordx4 v[108:111], v115, s[48:51], s74 offen offset:2048
v_fma_f32 v89, -v49, s76, v122
v_fma_f32 v66, v50, s76, -v120
v_fma_f32 v90, -v50, s76, v122
s_add_u32 s75, s73, 0
buffer_load_dwordx4 v[128:131], v114, s[48:51], s75 offen offset:0
v_fma_f32 v67, v51, s76, -v120
v_fma_f32 v91, -v51, s76, v122
v_exp_f32 v64, v64
buffer_load_dwordx4 v[132:135], v114, s[48:51], s75 offen offset:256
v_exp_f32 v88, v88
v_exp_f32 v65, v65
v_exp_f32 v89, v89
buffer_load_dwordx4 v[136:139], v114, s[48:51], s75 offen offset:2048
v_fma_f32 v68, v52, s76, -v120
v_fma_f32 v92, -v52, s76, v122
v_fma_f32 v69, v53, s76, -v120
buffer_load_dwordx4 v[140:143], v114, s[48:51], s75 offen offset:2304
v_fma_f32 v93, -v53, s76, v122
v_exp_f32 v66, v66
v_exp_f32 v90, v90
s_add_u32 s75, s73, 16384
buffer_load_dwordx4 v[144:147], v114, s[48:51], s75 offen offset:0
v_exp_f32 v67, v67
v_exp_f32 v91, v91
v_fma_f32 v70, v54, s76, -v120
buffer_load_dwordx4 v[148:151], v114, s[48:51], s75 offen offset:256
v_fma_f32 v94, -v54, s76, v122
v_fma_f32 v71, v55, s76, -v120
v_fma_f32 v95, -v55, s76, v122
buffer_load_dwordx4 v[152:155], v114, s[48:51], s75 offen offset:2048
v_exp_f32 v68, v68
v_exp_f32 v92, v92
v_exp_f32 v69, v69
buffer_load_dwordx4 v[156:159], v114, s[48:51], s75 offen offset:2304
v_exp_f32 v93, v93
v_add_f32 v6, v64, v66
v_add_f32 v7, v65, v67
s_add_u32 s75, s73, 32768
buffer_load_dwordx4 v[160:163], v114, s[48:51], s75 offen offset:0
v_add_f32 v8, v88, v90
v_add_f32 v9, v89, v91
v_fma_f32 v72, v56, s76, -v120
buffer_load_dwordx4 v[164:167], v114, s[48:51], s75 offen offset:256
v_fma_f32 v96, -v56, s76, v122
v_fma_f32 v73, v57, s76, -v120
v_fma_f32 v97, -v57, s76, v122
buffer_load_dwordx4 v[168:171], v114, s[48:51], s75 offen offset:2048
v_exp_f32 v70, v70
v_exp_f32 v94, v94
v_exp_f32 v71, v71
buffer_load_dwordx4 v[172:175], v114, s[48:51], s75 offen offset:2304
v_exp_f32 v95, v95
v_add_f32 v6, v6, v68
v_add_f32 v7, v7, v69
s_add_u32 s75, s73, 49152
buffer_load_dwordx4 v[176:179], v114, s[48:51], s75 offen offset:0
v_add_f32 v8, v8, v92
v_add_f32 v9, v9, v93
v_fma_f32 v74, v58, s76, -v120
buffer_load_dwordx4 v[180:183], v114, s[48:51], s75 offen offset:256
v_fma_f32 v98, -v58, s76, v122
v_fma_f32 v75, v59, s76, -v120
v_fma_f32 v99, -v59, s76, v122
buffer_load_dwordx4 v[184:187], v114, s[48:51], s75 offen offset:2048
v_exp_f32 v72, v72
v_exp_f32 v96, v96
v_exp_f32 v73, v73
buffer_load_dwordx4 v[188:191], v114, s[48:51], s75 offen offset:2304
v_exp_f32 v97, v97
v_add_f32 v6, v6, v70
v_add_f32 v7, v7, v71
v_add_f32 v8, v8, v94
s_barrier
ds_read_b64_tr_b16 v[192:193], v126 offset:0
v_add_f32 v9, v9, v95
v_fma_f32 v76, v60, s76, -v120
ds_read_b64_tr_b16 v[194:195], v126 offset:1024
v_fma_f32 v100, -v60, s76, v122
v_fma_f32 v77, v61, s76, -v120
ds_read_b64_tr_b16 v[196:197], v126 offset:2048
v_fma_f32 v101, -v61, s76, v122
v_exp_f32 v74, v74
ds_read_b64_tr_b16 v[198:199], v126 offset:3072
v_exp_f32 v98, v98
v_exp_f32 v75, v75
v_exp_f32 v99, v99
ds_read_b64_tr_b16 v[200:201], v126 offset:8192
v_add_f32 v6, v6, v72
v_add_f32 v7, v7, v73
ds_read_b64_tr_b16 v[202:203], v126 offset:9216
v_add_f32 v8, v8, v96
v_add_f32 v9, v9, v97
ds_read_b64_tr_b16 v[204:205], v126 offset:10240
v_fma_f32 v78, v62, s76, -v120
v_fma_f32 v102, -v62, s76, v122
v_fma_f32 v79, v63, s76, -v120
ds_read_b64_tr_b16 v[206:207], v126 offset:11264
v_fma_f32 v103, -v63, s76, v122
v_exp_f32 v76, v76
ds_read_b64_tr_b16 v[208:209], v126 offset:16384
v_exp_f32 v100, v100
v_exp_f32 v77, v77
ds_read_b64_tr_b16 v[210:211], v126 offset:17408
v_exp_f32 v101, v101
v_add_f32 v6, v6, v74
v_add_f32 v7, v7, v75
ds_read_b64_tr_b16 v[212:213], v126 offset:18432
v_add_f32 v8, v8, v98
v_add_f32 v9, v9, v99
ds_read_b64_tr_b16 v[214:215], v126 offset:19456
v_exp_f32 v78, v78
v_exp_f32 v102, v102
ds_read_b64_tr_b16 v[216:217], v126 offset:24576
v_exp_f32 v79, v79
v_exp_f32 v103, v103
v_add_f32 v6, v6, v76
ds_read_b64_tr_b16 v[218:219], v126 offset:25600
v_add_f32 v7, v7, v77
v_add_f32 v8, v8, v100
ds_read_b64_tr_b16 v[220:221], v126 offset:26624
v_add_f32 v9, v9, v101
v_add_f32 v6, v6, v78
ds_read_b64_tr_b16 v[222:223], v126 offset:27648
v_add_f32 v7, v7, v79
v_add_f32 v8, v8, v102
v_add_f32 v9, v9, v103
ds_read_b64_tr_b16 v[224:225], v125 offset:0
v_add_f32 v123, v8, v9
v_add_f32 v121, v6, v7
ds_read_b64_tr_b16 v[226:227], v125 offset:1024
v_rcp_f32 v122, v123
v_mul_f32 v120, 0x358637bd, v121
ds_read_b64_tr_b16 v[228:229], v125 offset:2048
v_mul_f32 v122, v122, v121
v_cvt_pk_bf16_f32 v48, v64, v65
ds_read_b64_tr_b16 v[230:231], v125 offset:3072
v_cvt_pk_bf16_f32 v49, v66, v67
v_cvt_pk_bf16_f32 v50, v68, v69
v_cvt_pk_bf16_f32 v51, v70, v71
ds_read_b64_tr_b16 v[232:233], v125 offset:8192
v_cvt_pk_bf16_f32 v52, v72, v73
v_cvt_pk_bf16_f32 v53, v74, v75
ds_read_b64_tr_b16 v[234:235], v125 offset:9216
v_cvt_pk_bf16_f32 v54, v76, v77
v_cvt_pk_bf16_f32 v55, v78, v79
ds_read_b64_tr_b16 v[236:237], v125 offset:10240
v_mul_f32 v88, v122, v88
v_mul_f32 v89, v122, v89
v_cvt_pk_bf16_f32 v56, v88, v89
ds_read_b64_tr_b16 v[238:239], v125 offset:11264
v_mul_f32 v90, v122, v90
v_mul_f32 v91, v122, v91
ds_read_b64_tr_b16 v[240:241], v125 offset:16384
v_cvt_pk_bf16_f32 v57, v90, v91
v_mul_f32 v92, v122, v92
ds_read_b64_tr_b16 v[242:243], v125 offset:17408
v_mul_f32 v93, v122, v93
v_cvt_pk_bf16_f32 v58, v92, v93
v_mul_f32 v94, v122, v94
ds_read_b64_tr_b16 v[244:245], v125 offset:18432
v_mul_f32 v95, v122, v95
v_cvt_pk_bf16_f32 v59, v94, v95
ds_read_b64_tr_b16 v[246:247], v125 offset:19456
v_mul_f32 v96, v122, v96
v_mul_f32 v97, v122, v97
ds_read_b64_tr_b16 v[248:249], v125 offset:24576
v_cvt_pk_bf16_f32 v60, v96, v97
v_mul_f32 v98, v122, v98
v_mul_f32 v99, v122, v99
ds_read_b64_tr_b16 v[250:251], v125 offset:25600
v_cvt_pk_bf16_f32 v61, v98, v99
v_mul_f32 v100, v122, v100
ds_read_b64_tr_b16 v[252:253], v125 offset:26624
v_mul_f32 v101, v122, v101
v_cvt_pk_bf16_f32 v62, v100, v101
ds_read_b64_tr_b16 v[254:255], v125 offset:27648
v_mul_f32 v102, v122, v102
v_mul_f32 v103, v122, v103
v_cvt_pk_bf16_f32 v63, v102, v103
s_mov_b32 s77, 0x10000
L_R:
s_waitcnt vmcnt(17)
v_mfma_f32_16x16x32_bf16 v[64:67], v[32:35], v[104:107], 0
v_max_u32 v2, v104, v106
s_waitcnt vmcnt(16)
v_mfma_f32_16x16x32_bf16 v[64:67], v[36:39], v[108:111], v[64:67]
v_max3_u32 v2, v2, v108, v110
s_waitcnt vmcnt(15)
v_mfma_f32_16x16x32_bf16 v[40:43], v[32:35], v[128:131], 0
v_max_u32 v6, v128, v130
s_waitcnt vmcnt(14)
v_mfma_f32_16x16x32_bf16 v[40:43], v[36:39], v[132:135], v[40:43]
v_max3_u32 v6, v6, v132, v134
s_waitcnt vmcnt(13)
v_mfma_f32_16x16x32_bf16 v[44:47], v[32:35], v[136:139], 0
v_max3_u32 v6, v6, v136, v138
s_waitcnt vmcnt(12)
v_mfma_f32_16x16x32_bf16 v[44:47], v[36:39], v[140:143], v[44:47]
v_max3_u32 v6, v6, v140, v142
s_waitcnt vmcnt(11)
v_mfma_f32_16x16x32_bf16 v[40:43], v[32:35], v[144:147], v[40:43]
v_max_u32 v7, v144, v146
s_waitcnt vmcnt(10)
v_mfma_f32_16x16x32_bf16 v[40:43], v[36:39], v[148:151], v[40:43]
v_max3_u32 v7, v7, v148, v150
s_waitcnt vmcnt(9)
v_mfma_f32_16x16x32_bf16 v[44:47], v[32:35], v[152:155], v[44:47]
v_max3_u32 v7, v7, v152, v154
s_waitcnt vmcnt(8)
v_mfma_f32_16x16x32_bf16 v[44:47], v[36:39], v[156:159], v[44:47]
v_max3_u32 v7, v7, v156, v158
s_waitcnt vmcnt(7)
v_mfma_f32_16x16x32_bf16 v[40:43], v[32:35], v[160:163], v[40:43]
v_max_u32 v8, v160, v162
v_cvt_pk_bf16_f32 v64, v64, v65
v_cvt_pk_bf16_f32 v65, v66, v67
ds_write_b64 v117, v[64:65]
s_waitcnt vmcnt(6)
v_mfma_f32_16x16x32_bf16 v[40:43], v[36:39], v[164:167], v[40:43]
v_max3_u32 v8, v8, v164, v166
s_waitcnt vmcnt(5)
v_mfma_f32_16x16x32_bf16 v[44:47], v[32:35], v[168:171], v[44:47]
v_max3_u32 v8, v8, v168, v170
s_waitcnt vmcnt(4)
v_mfma_f32_16x16x32_bf16 v[44:47], v[36:39], v[172:175], v[44:47]
v_max3_u32 v8, v8, v172, v174
s_waitcnt vmcnt(3)
v_mfma_f32_16x16x32_bf16 v[40:43], v[32:35], v[176:179], v[40:43]
v_max_u32 v9, v176, v178
v_max3_u32 v2, v2, v6, v7
s_waitcnt vmcnt(2)
v_mfma_f32_16x16x32_bf16 v[40:43], v[36:39], v[180:183], v[40:43]
v_max3_u32 v9, v9, v180, v182
s_waitcnt vmcnt(1)
v_mfma_f32_16x16x32_bf16 v[44:47], v[32:35], v[184:187], v[44:47]
v_max3_u32 v9, v9, v184, v186
s_waitcnt vmcnt(0)
v_mfma_f32_16x16x32_bf16 v[44:47], v[36:39], v[188:191], v[44:47]
v_max3_u32 v9, v9, v188, v190
v_max3_u32 v2, v2, v8, v9
v_cmp_eq_u32 vcc, -1, v2
v_cvt_pk_bf16_f32 v40, v40, v41
v_cvt_pk_bf16_f32 v41, v42, v43
ds_write_b64 v116, v[40:41] offset:0
s_nop 1
v_cvt_pk_bf16_f32 v44, v44, v45
v_cvt_pk_bf16_f32 v45, v46, v47
ds_write_b64 v116, v[44:45] offset:2048
s_cbranch_vccz L_A7
L_R2:
s_sub_u32 s77, s77, 1
s_cbranch_scc1 L_A7
buffer_load_dwordx4 v[104:107], v115, s[48:51], s74 offen offset:0 sc1
buffer_load_dwordx4 v[108:111], v115, s[48:51], s74 offen offset:2048 sc1
v_cmp_eq_u32 vcc, -1, v6
s_cbranch_vccz L_Rs2
s_add_u32 s75, s73, 0
buffer_load_dwordx4 v[128:131], v114, s[48:51], s75 offen offset:0 sc1
buffer_load_dwordx4 v[132:135], v114, s[48:51], s75 offen offset:256 sc1
buffer_load_dwordx4 v[136:139], v114, s[48:51], s75 offen offset:2048 sc1
buffer_load_dwordx4 v[140:143], v114, s[48:51], s75 offen offset:2304 sc1
L_Rs2:
v_cmp_eq_u32 vcc, -1, v7
s_cbranch_vccz L_Rs6
s_add_u32 s75, s73, 16384
buffer_load_dwordx4 v[144:147], v114, s[48:51], s75 offen offset:0 sc1
buffer_load_dwordx4 v[148:151], v114, s[48:51], s75 offen offset:256 sc1
buffer_load_dwordx4 v[152:155], v114, s[48:51], s75 offen offset:2048 sc1
buffer_load_dwordx4 v[156:159], v114, s[48:51], s75 offen offset:2304 sc1
L_Rs6:
v_cmp_eq_u32 vcc, -1, v8
s_cbranch_vccz L_Rs10
s_add_u32 s75, s73, 32768
buffer_load_dwordx4 v[160:163], v114, s[48:51], s75 offen offset:0 sc1
buffer_load_dwordx4 v[164:167], v114, s[48:51], s75 offen offset:256 sc1
buffer_load_dwordx4 v[168:171], v114, s[48:51], s75 offen offset:2048 sc1
buffer_load_dwordx4 v[172:175], v114, s[48:51], s75 offen offset:2304 sc1
L_Rs10:
v_cmp_eq_u32 vcc, -1, v9
s_cbranch_vccz L_Rs14
s_add_u32 s75, s73, 49152
buffer_load_dwordx4 v[176:179], v114, s[48:51], s75 offen offset:0 sc1
buffer_load_dwordx4 v[180:183], v114, s[48:51], s75 offen offset:256 sc1
buffer_load_dwordx4 v[184:187], v114, s[48:51], s75 offen offset:2048 sc1
buffer_load_dwordx4 v[188:191], v114, s[48:51], s75 offen offset:2304 sc1
L_Rs14:
s_waitcnt vmcnt(0)
s_waitcnt lgkmcnt(0)
s_branch L_R
L_A6:
s_nop 5
s_mov_b32 s75, 655360
s_bfe_u32 s3, s65, 0x40000
s_lshl_b32 s3, s3, 9
s_add_u32 s75, s75, s3
v_mov_b32 v14, s75
v_bfe_u32 v120, v1, 0, 5
v_lshl_add_u32 v14, v120, 4, v14
s_cmp_lg_u32 s70, 4
s_waitcnt vmcnt(0)
s_barrier
s_cbranch_scc1 L_A8
buffer_load_dword v15, v14, s[48:51], 0 offen sc1
L_A8:
s_add_u32 m0, s69, 0
s_xor_b32 s3, s63, 262144
buffer_load_dwordx4 v113, s[44:47], s3 offen offset:0 lds
v_max3_f32 v120, v48, v49, v50
v_max3_f32 v121, v51, v52, v53
v_min3_f32 v122, v48, v49, v50
ds_read_b64_tr_b16 v[192:193], v126 offset:0
v_min3_f32 v123, v51, v52, v53
v_max3_f32 v120, v120, v54, v55
v_max3_f32 v121, v121, v56, v57
ds_read_b64_tr_b16 v[194:195], v126 offset:1024
v_min3_f32 v122, v122, v54, v55
v_min3_f32 v123, v123, v56, v57
v_max3_f32 v120, v120, v58, v59
ds_read_b64_tr_b16 v[196:197], v126 offset:2048
v_max3_f32 v121, v121, v60, v61
v_min3_f32 v122, v122, v58, v59
ds_read_b64_tr_b16 v[198:199], v126 offset:3072
v_min3_f32 v123, v123, v60, v61
v_max3_f32 v120, v120, v62, v63
v_min3_f32 v122, v122, v62, v63
s_xor_b32 s3, s63, 265216
buffer_load_dwordx4 v113, s[44:47], s3 offen offset:1024 lds
v_max_f32 v120, v120, v121
v_min_f32 v122, v122, v123
v_mul_f32 v120, s76, v120
ds_read_b64_tr_b16 v[200:201], v126 offset:8192
v_mul_f32 v122, s76, v122
v_pk_fma_f32 v[64:65], v[48:49], s[76:77], v[120:121] op_sel_hi:[1,0,0] neg_lo:[0,0,1] neg_hi:[0,0,1]
v_pk_fma_f32 v[88:89], v[48:49], s[76:77], v[122:123] op_sel_hi:[1,0,0] neg_lo:[1,0,0] neg_hi:[1,0,0]
ds_read_b64_tr_b16 v[202:203], v126 offset:9216
v_pk_fma_f32 v[66:67], v[50:51], s[76:77], v[120:121] op_sel_hi:[1,0,0] neg_lo:[0,0,1] neg_hi:[0,0,1]
v_pk_fma_f32 v[90:91], v[50:51], s[76:77], v[122:123] op_sel_hi:[1,0,0] neg_lo:[1,0,0] neg_hi:[1,0,0]
ds_read_b64_tr_b16 v[204:205], v126 offset:10240
v_exp_f32 v64, v64
v_exp_f32 v88, v88
v_exp_f32 v65, v65
ds_read_b64_tr_b16 v[206:207], v126 offset:11264
v_exp_f32 v89, v89
v_pk_fma_f32 v[68:69], v[52:53], s[76:77], v[120:121] op_sel_hi:[1,0,0] neg_lo:[0,0,1] neg_hi:[0,0,1]
v_pk_fma_f32 v[92:93], v[52:53], s[76:77], v[122:123] op_sel_hi:[1,0,0] neg_lo:[1,0,0] neg_hi:[1,0,0]
s_xor_b32 s3, s63, 268288
buffer_load_dwordx4 v113, s[44:47], s3 offen offset:2048 lds
v_exp_f32 v66, v66
v_exp_f32 v90, v90
ds_read_b64_tr_b16 v[208:209], v126 offset:16384
v_exp_f32 v67, v67
v_exp_f32 v91, v91
v_pk_fma_f32 v[70:71], v[54:55], s[76:77], v[120:121] op_sel_hi:[1,0,0] neg_lo:[0,0,1] neg_hi:[0,0,1]
ds_read_b64_tr_b16 v[210:211], v126 offset:17408
v_pk_fma_f32 v[94:95], v[54:55], s[76:77], v[122:123] op_sel_hi:[1,0,0] neg_lo:[1,0,0] neg_hi:[1,0,0]
v_exp_f32 v68, v68
v_exp_f32 v92, v92
ds_read_b64_tr_b16 v[212:213], v126 offset:18432
v_exp_f32 v69, v69
v_exp_f32 v93, v93
v_pk_add_f32 v[6:7], v[64:65], v[66:67]
ds_read_b64_tr_b16 v[214:215], v126 offset:19456
v_pk_add_f32 v[8:9], v[88:89], v[90:91]
v_pk_fma_f32 v[72:73], v[56:57], s[76:77], v[120:121] op_sel_hi:[1,0,0] neg_lo:[0,0,1] neg_hi:[0,0,1]
s_xor_b32 s3, s63, 271360
buffer_load_dwordx4 v113, s[44:47], s3 offen offset:3072 lds
v_pk_fma_f32 v[96:97], v[56:57], s[76:77], v[122:123] op_sel_hi:[1,0,0] neg_lo:[1,0,0] neg_hi:[1,0,0]
v_exp_f32 v70, v70
v_exp_f32 v94, v94
ds_read_b64_tr_b16 v[216:217], v126 offset:24576
v_exp_f32 v71, v71
v_exp_f32 v95, v95
v_pk_add_f32 v[6:7], v[6:7], v[68:69]
ds_read_b64_tr_b16 v[218:219], v126 offset:25600
v_pk_add_f32 v[8:9], v[8:9], v[92:93]
v_pk_fma_f32 v[74:75], v[58:59], s[76:77], v[120:121] op_sel_hi:[1,0,0] neg_lo:[0,0,1] neg_hi:[0,0,1]
v_pk_fma_f32 v[98:99], v[58:59], s[76:77], v[122:123] op_sel_hi:[1,0,0] neg_lo:[1,0,0] neg_hi:[1,0,0]
ds_read_b64_tr_b16 v[220:221], v126 offset:26624
v_exp_f32 v72, v72
v_exp_f32 v96, v96
ds_read_b64_tr_b16 v[222:223], v126 offset:27648
v_exp_f32 v73, v73
v_exp_f32 v97, v97
v_pk_add_f32 v[6:7], v[6:7], v[70:71]
s_add_u32 m0, s69, 16384
s_xor_b32 s3, s63, 327680
buffer_load_dwordx4 v113, s[44:47], s3 offen offset:0 lds
v_pk_add_f32 v[8:9], v[8:9], v[94:95]
v_pk_fma_f32 v[76:77], v[60:61], s[76:77], v[120:121] op_sel_hi:[1,0,0] neg_lo:[0,0,1] neg_hi:[0,0,1]
v_pk_fma_f32 v[100:101], v[60:61], s[76:77], v[122:123] op_sel_hi:[1,0,0] neg_lo:[1,0,0] neg_hi:[1,0,0]
ds_read_b64_tr_b16 v[224:225], v125 offset:0
v_exp_f32 v74, v74
v_exp_f32 v98, v98
ds_read_b64_tr_b16 v[226:227], v125 offset:1024
v_exp_f32 v75, v75
v_exp_f32 v99, v99
v_pk_add_f32 v[6:7], v[6:7], v[72:73]
ds_read_b64_tr_b16 v[228:229], v125 offset:2048
v_pk_add_f32 v[8:9], v[8:9], v[96:97]
v_pk_fma_f32 v[78:79], v[62:63], s[76:77], v[120:121] op_sel_hi:[1,0,0] neg_lo:[0,0,1] neg_hi:[0,0,1]
v_pk_fma_f32 v[102:103], v[62:63], s[76:77], v[122:123] op_sel_hi:[1,0,0] neg_lo:[1,0,0] neg_hi:[1,0,0]
ds_read_b64_tr_b16 v[230:231], v125 offset:3072
v_exp_f32 v76, v76
v_exp_f32 v100, v100
v_exp_f32 v77, v77
s_xor_b32 s3, s63, 330752
buffer_load_dwordx4 v113, s[44:47], s3 offen offset:1024 lds
v_exp_f32 v101, v101
v_pk_add_f32 v[6:7], v[6:7], v[74:75]
ds_read_b64_tr_b16 v[232:233], v125 offset:8192
v_pk_add_f32 v[8:9], v[8:9], v[98:99]
v_exp_f32 v78, v78
v_exp_f32 v102, v102
ds_read_b64_tr_b16 v[234:235], v125 offset:9216
v_exp_f32 v79, v79
v_exp_f32 v103, v103
v_pk_add_f32 v[6:7], v[6:7], v[76:77]
ds_read_b64_tr_b16 v[236:237], v125 offset:10240
v_pk_add_f32 v[8:9], v[8:9], v[100:101]
v_pk_add_f32 v[6:7], v[6:7], v[78:79]
v_pk_add_f32 v[8:9], v[8:9], v[102:103]
ds_read_b64_tr_b16 v[238:239], v125 offset:11264
v_add_f32 v123, v8, v9
v_add_f32 v121, v6, v7
s_xor_b32 s3, s63, 333824
buffer_load_dwordx4 v113, s[44:47], s3 offen offset:2048 lds
v_rcp_f32 v122, v123
v_mul_f32 v120, 0x358637bd, v121
v_mul_f32 v122, v122, v121
ds_read_b64_tr_b16 v[240:241], v125 offset:16384
v_cvt_pk_bf16_f32 v48, v64, v65
v_cvt_pk_bf16_f32 v49, v66, v67
v_cvt_pk_bf16_f32 v50, v68, v69
ds_read_b64_tr_b16 v[242:243], v125 offset:17408
v_cvt_pk_bf16_f32 v51, v70, v71
v_cvt_pk_bf16_f32 v52, v72, v73
ds_read_b64_tr_b16 v[244:245], v125 offset:18432
v_cvt_pk_bf16_f32 v53, v74, v75
v_cvt_pk_bf16_f32 v54, v76, v77
v_cvt_pk_bf16_f32 v55, v78, v79
ds_read_b64_tr_b16 v[246:247], v125 offset:19456
v_pk_mul_f32 v[88:89], v[88:89], v[122:123] op_sel_hi:[1,0]
v_cvt_pk_bf16_f32 v56, v88, v89
v_pk_mul_f32 v[90:91], v[90:91], v[122:123] op_sel_hi:[1,0]
s_xor_b32 s3, s63, 336896
buffer_load_dwordx4 v113, s[44:47], s3 offen offset:3072 lds
v_cvt_pk_bf16_f32 v57, v90, v91
v_pk_mul_f32 v[92:93], v[92:93], v[122:123] op_sel_hi:[1,0]
v_cvt_pk_bf16_f32 v58, v92, v93
ds_read_b64_tr_b16 v[248:249], v125 offset:24576
v_pk_mul_f32 v[94:95], v[94:95], v[122:123] op_sel_hi:[1,0]
v_cvt_pk_bf16_f32 v59, v94, v95
ds_read_b64_tr_b16 v[250:251], v125 offset:25600
v_pk_mul_f32 v[96:97], v[96:97], v[122:123] op_sel_hi:[1,0]
v_cvt_pk_bf16_f32 v60, v96, v97
v_pk_mul_f32 v[98:99], v[98:99], v[122:123] op_sel_hi:[1,0]
ds_read_b64_tr_b16 v[252:253], v125 offset:26624
v_cvt_pk_bf16_f32 v61, v98, v99
v_pk_mul_f32 v[100:101], v[100:101], v[122:123] op_sel_hi:[1,0]
v_cvt_pk_bf16_f32 v62, v100, v101
ds_read_b64_tr_b16 v[254:255], v125 offset:27648
v_pk_mul_f32 v[102:103], v[102:103], v[122:123] op_sel_hi:[1,0]
v_cvt_pk_bf16_f32 v63, v102, v103
s_cmp_lg_u32 s70, 4
s_cbranch_scc1 L_G2_y
s_mov_b32 s3, 0x100000
s_waitcnt vmcnt(8)
L_G2:
v_cmp_eq_u32 vcc, -1, v15
s_cbranch_vccz L_G2_y
buffer_load_dword v15, v14, s[48:51], 0 offen sc1
s_sub_u32 s3, s3, 1
s_waitcnt vmcnt(0)
s_cbranch_scc0 L_G2
L_G2_y:
L_A7:
s_waitcnt lgkmcnt(0)
s_barrier
ds_read_b128 v[88:91], v119 offset:0
ds_read_b128 v[92:95], v119 offset:16
ds_read_b128 v[96:99], v119 offset:32
ds_read_b128 v[100:103], v119 offset:48
ds_read_b128 v[16:19], v118 offset:0
ds_read_b128 v[20:23], v118 offset:16
ds_read_b128 v[24:27], v118 offset:512
ds_read_b128 v[28:31], v118 offset:528
s_mov_b64 exec, -1
s_add_u32 m0, s71, 32768
s_xor_b32 s3, s66, 393216
buffer_load_dwordx4 v113, s[44:47], s3 offen offset:0 lds
s_waitcnt lgkmcnt(7)
v_mfma_f32_16x16x32_bf16 v[32:35], v[88:91], v[48:51], 0
s_waitcnt lgkmcnt(6)
v_mfma_f32_16x16x32_bf16 v[32:35], v[92:95], v[52:55], v[32:35]
s_xor_b32 s3, s66, 396288
buffer_load_dwordx4 v113, s[44:47], s3 offen offset:1024 lds
s_waitcnt lgkmcnt(5)
v_mfma_f32_16x16x32_bf16 v[32:35], v[96:99], v[56:59], v[32:35]
s_waitcnt lgkmcnt(4)
v_mfma_f32_16x16x32_bf16 v[32:35], v[100:103], v[60:63], v[32:35]
s_xor_b32 s3, s66, 399360
buffer_load_dwordx4 v113, s[44:47], s3 offen offset:2048 lds
s_waitcnt lgkmcnt(3)
v_mfma_f32_32x32x16_bf16 v[64:79], v[16:19], v[48:51], 0
s_waitcnt lgkmcnt(2)
v_mfma_f32_32x32x16_bf16 v[64:79], v[20:23], v[52:55], v[64:79]
s_xor_b32 s3, s66, 402432
buffer_load_dwordx4 v113, s[44:47], s3 offen offset:3072 lds
s_waitcnt lgkmcnt(1)
v_mfma_f32_32x32x16_bf16 v[64:79], v[24:27], v[56:59], v[64:79]
s_waitcnt lgkmcnt(0)
v_mfma_f32_32x32x16_bf16 v[64:79], v[28:31], v[60:63], v[64:79]
s_mov_b32 s72, 1064960
s_bfe_u32 s3, s65, 0x40000
s_lshl_b32 s3, s3, 17
s_add_u32 s72, s72, s3
s_bfe_u32 s3, s64, 0x10002
s_lshl_b32 s3, s3, 16
s_add_u32 s72, s72, s3
s_bfe_u32 s3, s70, 0x10002
s_lshl_b32 s3, s3, 15
s_add_u32 s72, s72, s3
s_bfe_u32 s3, s70, 0x20000
s_lshl_b32 s3, s3, 12
s_add_u32 s72, s72, s3
s_xor_b32 s73, s72, 0x4000
s_mov_b32 m0, s67
s_mov_b32 s77, 0x10000
v_add_f32 v32, v32, v33
v_add_f32 v34, v34, v35
v_add_f32 v32, v32, v120
v_add_f32 v32, v32, v34
v_rcp_f32 v32, v32
s_nop 0
v_pk_mul_f32 v[64:65], v[64:65], v[32:33] op_sel_hi:[1,0]
v_cvt_pk_bf16_f32 v16, v64, v65
v_pk_mul_f32 v[66:67], v[66:67], v[32:33] op_sel_hi:[1,0]
v_cvt_pk_bf16_f32 v17, v66, v67
v_pk_mul_f32 v[68:69], v[68:69], v[32:33] op_sel_hi:[1,0]
v_cvt_pk_bf16_f32 v18, v68, v69
v_pk_mul_f32 v[70:71], v[70:71], v[32:33] op_sel_hi:[1,0]
v_cvt_pk_bf16_f32 v19, v70, v71
buffer_store_dwordx4 v[16:19], v5, s[48:51], s60 offen offset:0 sc1
v_pk_mul_f32 v[72:73], v[72:73], v[32:33] op_sel_hi:[1,0]
v_cvt_pk_bf16_f32 v20, v72, v73
v_pk_mul_f32 v[74:75], v[74:75], v[32:33] op_sel_hi:[1,0]
v_cvt_pk_bf16_f32 v21, v74, v75
v_pk_mul_f32 v[76:77], v[76:77], v[32:33] op_sel_hi:[1,0]
v_cvt_pk_bf16_f32 v22, v76, v77
v_pk_mul_f32 v[78:79], v[78:79], v[32:33] op_sel_hi:[1,0]
v_cvt_pk_bf16_f32 v23, v78, v79
buffer_store_dwordx4 v[20:23], v5, s[48:51], s60 offen offset:1024 sc1
s_mov_b32 s74, 0
s_bfe_u32 s3, s65, 0x40000
s_lshl_b32 s3, s3, 18
s_add_u32 s74, s74, s3
s_bfe_u32 s3, s64, 0x10002
s_lshl_b32 s3, s3, 17
s_add_u32 s74, s74, s3
s_bfe_u32 s3, s70, 0x10000
s_lshl_b32 s3, s3, 16
s_add_u32 s74, s74, s3
s_bfe_u32 s3, s64, 0x20000
s_lshl_b32 s3, s3, 8
s_add_u32 s74, s74, s3
s_bfe_u32 s3, s70, 0x20001
s_lshl_b32 s3, s3, 6
s_add_u32 s74, s74, s3
s_waitcnt vmcnt(0)
s_barrier
buffer_load_dwordx4 v5, s[48:51], s72 offen offset:0 sc1 lds
buffer_load_dwordx4 v5, s[48:51], s72 offen offset:1024 sc1 lds
buffer_load_dwordx4 v5, s[48:51], s72 offen offset:2048 sc1 lds
buffer_load_dwordx4 v5, s[48:51], s72 offen offset:3072 sc1 lds
L_O0:
s_waitcnt vmcnt(0)
L_O0b:
ds_read_b32 v32, v12 offset:0
ds_read_b32 v33, v12 offset:1024
ds_read_b32 v34, v12 offset:2048
ds_read_b32 v35, v12 offset:3072
s_waitcnt lgkmcnt(1)
v_max3_u32 v40, v32, v33, v34
s_waitcnt lgkmcnt(0)
v_max_u32 v40, v40, v35
v_cmp_eq_u32 vcc, -1, v40
s_cbranch_vccz L_P0
s_sub_u32 s77, s77, 1
s_cbranch_scc1 L_P0
v_cmp_eq_u32 vcc, -1, v32
s_cbranch_vccz L_Os00
buffer_load_dwordx4 v5, s[48:51], s72 offen offset:0 sc1 lds
L_Os00:
v_cmp_eq_u32 vcc, -1, v33
s_cbranch_vccz L_Os01
buffer_load_dwordx4 v5, s[48:51], s72 offen offset:1024 sc1 lds
L_Os01:
v_cmp_eq_u32 vcc, -1, v34
s_cbranch_vccz L_Os02
buffer_load_dwordx4 v5, s[48:51], s72 offen offset:2048 sc1 lds
L_Os02:
v_cmp_eq_u32 vcc, -1, v35
s_cbranch_vccz L_Os03
buffer_load_dwordx4 v5, s[48:51], s72 offen offset:3072 sc1 lds
L_Os03:
s_branch L_O0
L_P0:
s_add_u32 m0, s67, 16384
s_mov_b32 s77, 0x10000
buffer_load_dwordx4 v5, s[48:51], s73 offen offset:0 sc1 lds
buffer_load_dwordx4 v5, s[48:51], s73 offen offset:1024 sc1 lds
buffer_load_dwordx4 v5, s[48:51], s73 offen offset:2048 sc1 lds
buffer_load_dwordx4 v5, s[48:51], s73 offen offset:3072 sc1 lds
s_barrier
ds_read_b128 v[48:51], v127 offset:0
ds_read_b128 v[52:55], v127 offset:1024
ds_read_b128 v[56:59], v127 offset:2048
ds_read_b128 v[60:63], v127 offset:3072
ds_read_b128 v[64:67], v127 offset:4096
ds_read_b64_tr_b16 v[128:129], v124 offset:0
ds_read_b64_tr_b16 v[130:131], v124 offset:1024
s_waitcnt lgkmcnt(6)
v_mfma_f32_32x32x16_bf16 v[16:31], v[192:195], v[48:51], 0
ds_read_b128 v[68:71], v127 offset:5120
ds_read_b64_tr_b16 v[132:133], v124 offset:2048
ds_read_b64_tr_b16 v[134:135], v124 offset:3072
s_waitcnt lgkmcnt(8)
v_mfma_f32_32x32x16_bf16 v[16:31], v[196:199], v[52:55], v[16:31]
ds_read_b128 v[72:75], v127 offset:6144
ds_read_b64_tr_b16 v[136:137], v124 offset:8192
ds_read_b64_tr_b16 v[138:139], v124 offset:9216
s_waitcnt lgkmcnt(10)
v_mfma_f32_32x32x16_bf16 v[16:31], v[200:203], v[56:59], v[16:31]
ds_read_b128 v[76:79], v127 offset:7168
ds_read_b64_tr_b16 v[140:141], v124 offset:10240
ds_read_b64_tr_b16 v[142:143], v124 offset:11264
s_waitcnt lgkmcnt(12)
v_mfma_f32_32x32x16_bf16 v[16:31], v[204:207], v[60:63], v[16:31]
ds_read_b128 v[48:51], v127 offset:8192
ds_read_b64_tr_b16 v[144:145], v124 offset:16384
ds_read_b64_tr_b16 v[146:147], v124 offset:17408
s_waitcnt lgkmcnt(14)
v_mfma_f32_32x32x16_bf16 v[16:31], v[208:211], v[64:67], v[16:31]
ds_read_b128 v[52:55], v127 offset:9216
ds_read_b64_tr_b16 v[148:149], v124 offset:18432
ds_read_b64_tr_b16 v[150:151], v124 offset:19456
s_waitcnt lgkmcnt(14)
v_mfma_f32_32x32x16_bf16 v[16:31], v[212:215], v[68:71], v[16:31]
ds_read_b128 v[56:59], v127 offset:10240
ds_read_b64_tr_b16 v[152:153], v124 offset:24576
ds_read_b64_tr_b16 v[154:155], v124 offset:25600
s_waitcnt lgkmcnt(14)
v_mfma_f32_32x32x16_bf16 v[16:31], v[216:219], v[72:75], v[16:31]
ds_read_b128 v[60:63], v127 offset:11264
ds_read_b64_tr_b16 v[156:157], v124 offset:26624
ds_read_b64_tr_b16 v[158:159], v124 offset:27648
s_waitcnt lgkmcnt(14)
v_mfma_f32_32x32x16_bf16 v[16:31], v[220:223], v[76:79], v[16:31]
ds_read_b128 v[64:67], v127 offset:12288
ds_read_b64_tr_b16 v[160:161], v124 offset:32768
ds_read_b64_tr_b16 v[162:163], v124 offset:33792
s_waitcnt lgkmcnt(14)
v_mfma_f32_32x32x16_bf16 v[16:31], v[224:227], v[48:51], v[16:31]
ds_read_b128 v[68:71], v127 offset:13312
ds_read_b64_tr_b16 v[164:165], v124 offset:34816
ds_read_b64_tr_b16 v[166:167], v124 offset:35840
s_waitcnt lgkmcnt(14)
v_mfma_f32_32x32x16_bf16 v[16:31], v[228:231], v[52:55], v[16:31]
ds_read_b128 v[72:75], v127 offset:14336
ds_read_b64_tr_b16 v[168:169], v124 offset:40960
ds_read_b64_tr_b16 v[170:171], v124 offset:41984
s_waitcnt lgkmcnt(14)
v_mfma_f32_32x32x16_bf16 v[16:31], v[232:235], v[56:59], v[16:31]
ds_read_b128 v[76:79], v127 offset:15360
ds_read_b64_tr_b16 v[172:173], v124 offset:43008
ds_read_b64_tr_b16 v[174:175], v124 offset:44032
s_waitcnt lgkmcnt(14)
v_mfma_f32_32x32x16_bf16 v[16:31], v[236:239], v[60:63], v[16:31]
ds_read_b64_tr_b16 v[176:177], v124 offset:49152
ds_read_b64_tr_b16 v[178:179], v124 offset:50176
s_waitcnt lgkmcnt(13)
v_mfma_f32_32x32x16_bf16 v[16:31], v[240:243], v[64:67], v[16:31]
ds_read_b64_tr_b16 v[180:181], v124 offset:51200
ds_read_b64_tr_b16 v[182:183], v124 offset:52224
s_waitcnt lgkmcnt(12)
v_mfma_f32_32x32x16_bf16 v[16:31], v[244:247], v[68:71], v[16:31]
ds_read_b64_tr_b16 v[184:185], v124 offset:57344
ds_read_b64_tr_b16 v[186:187], v124 offset:58368
s_waitcnt lgkmcnt(11)
v_mfma_f32_32x32x16_bf16 v[16:31], v[248:251], v[72:75], v[16:31]
ds_read_b64_tr_b16 v[188:189], v124 offset:59392
ds_read_b64_tr_b16 v[190:191], v124 offset:60416
s_waitcnt lgkmcnt(10)
v_mfma_f32_32x32x16_bf16 v[16:31], v[252:255], v[76:79], v[16:31]
L_O1:
s_waitcnt vmcnt(0)
L_O1b:
ds_read_b32 v32, v12 offset:16384
ds_read_b32 v33, v12 offset:17408
ds_read_b32 v34, v12 offset:18432
ds_read_b32 v35, v12 offset:19456
s_waitcnt lgkmcnt(1)
v_max3_u32 v40, v32, v33, v34
s_waitcnt lgkmcnt(0)
v_max_u32 v40, v40, v35
v_cmp_eq_u32 vcc, -1, v40
s_cbranch_vccz L_P1
s_sub_u32 s77, s77, 1
s_cbranch_scc1 L_P1
v_cmp_eq_u32 vcc, -1, v32
s_cbranch_vccz L_Os10
buffer_load_dwordx4 v5, s[48:51], s73 offen offset:0 sc1 lds
L_Os10:
v_cmp_eq_u32 vcc, -1, v33
s_cbranch_vccz L_Os11
buffer_load_dwordx4 v5, s[48:51], s73 offen offset:1024 sc1 lds
L_Os11:
v_cmp_eq_u32 vcc, -1, v34
s_cbranch_vccz L_Os12
buffer_load_dwordx4 v5, s[48:51], s73 offen offset:2048 sc1 lds
L_Os12:
v_cmp_eq_u32 vcc, -1, v35
s_cbranch_vccz L_Os13
buffer_load_dwordx4 v5, s[48:51], s73 offen offset:3072 sc1 lds
L_Os13:
s_branch L_O1
L_P1:
s_barrier
ds_read_b128 v[48:51], v127 offset:16384
ds_read_b128 v[52:55], v127 offset:17408
ds_read_b128 v[56:59], v127 offset:18432
ds_read_b128 v[60:63], v127 offset:19456
ds_read_b128 v[64:67], v127 offset:20480
s_waitcnt lgkmcnt(4)
v_mfma_f32_32x32x16_bf16 v[16:31], v[128:131], v[48:51], v[16:31]
ds_read_b128 v[68:71], v127 offset:21504
s_waitcnt lgkmcnt(4)
v_mfma_f32_32x32x16_bf16 v[16:31], v[132:135], v[52:55], v[16:31]
ds_read_b128 v[72:75], v127 offset:22528
s_waitcnt lgkmcnt(4)
v_mfma_f32_32x32x16_bf16 v[16:31], v[136:139], v[56:59], v[16:31]
ds_read_b128 v[76:79], v127 offset:23552
s_waitcnt lgkmcnt(4)
v_mfma_f32_32x32x16_bf16 v[16:31], v[140:143], v[60:63], v[16:31]
ds_read_b128 v[48:51], v127 offset:24576
s_waitcnt lgkmcnt(4)
v_mfma_f32_32x32x16_bf16 v[16:31], v[144:147], v[64:67], v[16:31]
ds_read_b128 v[52:55], v127 offset:25600
s_waitcnt lgkmcnt(4)
v_mfma_f32_32x32x16_bf16 v[16:31], v[148:151], v[68:71], v[16:31]
ds_read_b128 v[56:59], v127 offset:26624
s_waitcnt lgkmcnt(4)
v_mfma_f32_32x32x16_bf16 v[16:31], v[152:155], v[72:75], v[16:31]
ds_read_b128 v[60:63], v127 offset:27648
s_waitcnt lgkmcnt(4)
v_mfma_f32_32x32x16_bf16 v[16:31], v[156:159], v[76:79], v[16:31]
ds_read_b128 v[64:67], v127 offset:28672
s_waitcnt lgkmcnt(4)
v_mfma_f32_32x32x16_bf16 v[16:31], v[160:163], v[48:51], v[16:31]
ds_read_b128 v[68:71], v127 offset:29696
s_waitcnt lgkmcnt(4)
v_mfma_f32_32x32x16_bf16 v[16:31], v[164:167], v[52:55], v[16:31]
ds_read_b128 v[72:75], v127 offset:30720
s_waitcnt lgkmcnt(4)
v_mfma_f32_32x32x16_bf16 v[16:31], v[168:171], v[56:59], v[16:31]
ds_read_b128 v[76:79], v127 offset:31744
s_waitcnt lgkmcnt(4)
v_mfma_f32_32x32x16_bf16 v[16:31], v[172:175], v[60:63], v[16:31]
s_waitcnt lgkmcnt(3)
v_mfma_f32_32x32x16_bf16 v[16:31], v[176:179], v[64:67], v[16:31]
s_waitcnt lgkmcnt(2)
v_mfma_f32_32x32x16_bf16 v[16:31], v[180:183], v[68:71], v[16:31]
s_waitcnt lgkmcnt(1)
v_mfma_f32_32x32x16_bf16 v[16:31], v[184:187], v[72:75], v[16:31]
s_waitcnt lgkmcnt(0)
v_mfma_f32_32x32x16_bf16 v[16:31], v[188:191], v[76:79], v[16:31]
s_nop 11
v_cvt_pk_bf16_f32 v32, v16, v17
v_cvt_pk_bf16_f32 v33, v18, v19
v_cvt_pk_bf16_f32 v34, v20, v21
v_cvt_pk_bf16_f32 v35, v22, v23
v_cvt_pk_bf16_f32 v36, v24, v25
v_cvt_pk_bf16_f32 v37, v26, v27
v_cvt_pk_bf16_f32 v38, v28, v29
v_cvt_pk_bf16_f32 v39, v30, v31
buffer_store_dwordx4 v[32:35], v11, s[52:55], s74 offen
buffer_store_dwordx4 v[36:39], v11, s[52:55], s74 offen offset:16
s_endpgm
L_B:
s_sub_u32 s3, s2, 128
s_and_b32 s64, s3, 7
s_lshl_b32 s64, s64, 7
s_and_b32 s65, s3, 0x78
s_add_u32 s64, s64, s65
s_and_b32 s66, s70, 3
s_lshr_b32 s67, s70, 2
s_lshl_b32 s68, s66, 1
s_add_u32 s69, s64, s68
s_add_u32 s69, s69, s67
s_lshl_b32 s69, s69, 7
v_lshl_add_u32 v2, v1, 1, s69
v_lshl_add_u32 v3, v0, 12, s64
s_waitcnt lgkmcnt(0)
s_load_dwordx2 s[56:57], s[22:23], s64
s_load_dwordx2 s[58:59], s[24:25], s64
s_mov_b32 s36, s14
s_mov_b32 s37, s15
s_mov_b32 s38, 0x20000
s_mov_b32 s39, 0x20000
s_mov_b32 s40, s16
s_mov_b32 s41, s17
s_mov_b32 s42, 0x20000
s_mov_b32 s43, 0x20000
s_mov_b32 s44, s18
s_mov_b32 s45, s19
s_mov_b32 s46, 0x20000
s_mov_b32 s47, 0x20000
s_mov_b32 s48, s20
s_mov_b32 s49, s21
s_mov_b32 s50, 0x20000
s_mov_b32 s51, 0x20000
buffer_load_ushort v4, v2, s[36:39], 0 offen
buffer_load_ushort v5, v2, s[40:43], 0 offen
buffer_load_ushort v6, v2, s[44:47], 0 offen
buffer_load_ushort v7, v2, s[48:51], 0 offen
s_mov_b32 s32, s12
s_mov_b32 s33, s13
s_mov_b32 s34, 0x200000
s_mov_b32 s35, 0x20000
s_mov_b32 s52, s26
s_mov_b32 s53, s27
s_mov_b32 s54, 0x400000
s_mov_b32 s55, 0x20000
s_barrier
v_subrev_u32 v18, 0x400, v3
s_mov_b64 exec, 1
buffer_load_dwordx2 v[16:17], v18, s[32:35], 0 offen
s_mov_b64 exec, -1
v_lshrrev_b32 v18, 3, v1
v_mul_u32_u24 v18, 4160, v18
v_and_b32 v19, 7, v1
v_lshl_add_u32 v18, v19, 2, v18
v_add_u32 v18, 121776, v18
v_mov_b32 v19, 0
ds_write_b32 v18, v19
s_add_u32 s71, s68, s67
s_lshl_b32 s71, s71, 8
s_mov_b32 m0, s71
s_lshl_b32 s72, s66, 4
s_waitcnt lgkmcnt(0)
s_lshr_b64 s[56:57], s[56:57], s72
s_lshr_b64 s[58:59], s[58:59], s72
s_lshl_b32 s56, s56, 16
s_lshl_b32 s58, s58, 16
v_mov_b32 v20, s56
v_mul_f32 v22, 0x3fb8aa00, v20
v_rndne_f32 v23, v22
v_sub_f32 v22, v22, v23
v_fmac_f32 v22, 0x36eca570, v20
v_exp_f32 v22, v22
v_cvt_i32_f32 v23, v23
v_ldexp_f32 v22, v22, v23
v_cvt_pk_bf16_f32 v22, v22, v22
v_and_b32 v20, 0xffff0000, v22
s_waitcnt vmcnt(1)
v_lshlrev_b32 v4, 16, v4
v_lshlrev_b32 v5, 16, v5
v_lshlrev_b32 v6, 16, v6
v_lshlrev_b32 v7, 16, v7
v_mul_f32 v22, 0x3fb8aa00, v4
v_rndne_f32 v23, v22
v_sub_f32 v22, v22, v23
v_fmac_f32 v22, 0x36eca570, v4
v_exp_f32 v22, v22
v_cvt_i32_f32 v23, v23
v_ldexp_f32 v22, v22, v23
v_cvt_pk_bf16_f32 v22, v22, v22
v_and_b32 v4, 0xffff0000, v22
v_mul_f32 v4, v4, v20
v_mul_f32 v5, v5, v20
v_mul_f32 v4, 0xbfb8aa3b, v4
v_mul_f32 v5, 0x3e22f983, v5
v_add_f32 v20, v20, v20
v_mul_f32 v60, v6, v20
v_mul_f32 v61, v7, -v20
v_mul_f32 v22, 0x41000000, v4
v_mul_f32 v23, 0x41000000, v5
v_exp_f32 v22, v22
v_fract_f32 v23, v23
v_cos_f32 v32, v23
v_sin_f32 v33, v23
s_nop 0
v_pk_mul_f32 v[32:33], v[32:33], v[22:23] op_sel_hi:[1,0]
v_mul_f32 v22, 1.0, v4
v_mul_f32 v23, 1.0, v5
v_exp_f32 v22, v22
v_fract_f32 v23, v23
v_cos_f32 v30, v23
v_sin_f32 v31, v23
s_nop 0
v_pk_mul_f32 v[30:31], v[30:31], v[22:23] op_sel_hi:[1,0]
v_mul_f32 v22, 0x43800000, v4
v_mul_f32 v23, 0x43800000, v5
v_exp_f32 v22, v22
v_fract_f32 v23, v23
v_cos_f32 v34, v23
v_sin_f32 v35, v23
s_nop 0
v_pk_mul_f32 v[34:35], v[34:35], v[22:23] op_sel_hi:[1,0]
v_mov_b32 v22, 1.0
v_mov_b32 v23, 0
v_pk_mul_f32 v[44:45], v[32:33], v[32:33] op_sel_hi:[1,0]
v_pk_mul_f32 v[46:47], v[30:31], v[30:31] op_sel_hi:[1,0]
v_pk_fma_f32 v[24:25], v[32:33], v[32:33], v[44:45] op_sel:[1,1,0] op_sel_hi:[0,1,1] neg_lo:[1,0,0]
v_pk_fma_f32 v[36:37], v[30:31], v[30:31], v[46:47] op_sel:[1,1,0] op_sel_hi:[0,1,1] neg_lo:[1,0,0]
v_pk_mul_f32 v[44:45], v[24:25], v[32:33] op_sel_hi:[1,0]
v_pk_mul_f32 v[46:47], v[24:25], v[24:25] op_sel_hi:[1,0]
v_pk_mul_f32 v[48:49], v[36:37], v[36:37] op_sel_hi:[1,0]
v_pk_fma_f32 v[26:27], v[24:25], v[32:33], v[44:45] op_sel:[1,1,0] op_sel_hi:[0,1,1] neg_lo:[1,0,0]
v_pk_fma_f32 v[40:41], v[24:25], v[24:25], v[46:47] op_sel:[1,1,0] op_sel_hi:[0,1,1] neg_lo:[1,0,0]
v_pk_fma_f32 v[38:39], v[36:37], v[36:37], v[48:49] op_sel:[1,1,0] op_sel_hi:[0,1,1] neg_lo:[1,0,0]
v_cvt_pk_bf16_f32 v54, v22, v23
ds_write_addtid_b32 v54 offset:0
v_cvt_pk_bf16_f32 v55, v32, v33
ds_write_addtid_b32 v55 offset:2064
v_cvt_pk_bf16_f32 v56, v24, v25
ds_write_addtid_b32 v56 offset:4128
v_cvt_pk_bf16_f32 v57, v26, v27
ds_write_addtid_b32 v57 offset:6192
v_pk_mul_f32 v[44:45], v[22:23], v[40:41] op_sel_hi:[1,0]
v_pk_mul_f32 v[46:47], v[32:33], v[40:41] op_sel_hi:[1,0]
v_pk_mul_f32 v[48:49], v[24:25], v[40:41] op_sel_hi:[1,0]
v_pk_mul_f32 v[50:51], v[26:27], v[40:41] op_sel_hi:[1,0]
v_pk_fma_f32 v[22:23], v[22:23], v[40:41], v[44:45] op_sel:[1,1,0] op_sel_hi:[0,1,1] neg_lo:[1,0,0]
v_pk_fma_f32 v[28:29], v[32:33], v[40:41], v[46:47] op_sel:[1,1,0] op_sel_hi:[0,1,1] neg_lo:[1,0,0]
v_pk_fma_f32 v[24:25], v[24:25], v[40:41], v[48:49] op_sel:[1,1,0] op_sel_hi:[0,1,1] neg_lo:[1,0,0]
v_pk_fma_f32 v[26:27], v[26:27], v[40:41], v[50:51] op_sel:[1,1,0] op_sel_hi:[0,1,1] neg_lo:[1,0,0]
v_cvt_pk_bf16_f32 v54, v22, v23
ds_write_addtid_b32 v54 offset:8256
v_cvt_pk_bf16_f32 v55, v28, v29
ds_write_addtid_b32 v55 offset:10320
v_cvt_pk_bf16_f32 v56, v24, v25
ds_write_addtid_b32 v56 offset:12384
v_cvt_pk_bf16_f32 v57, v26, v27
ds_write_addtid_b32 v57 offset:14448
v_pk_mul_f32 v[44:45], v[22:23], v[40:41] op_sel_hi:[1,0]
v_pk_mul_f32 v[46:47], v[28:29], v[40:41] op_sel_hi:[1,0]
v_pk_mul_f32 v[48:49], v[24:25], v[40:41] op_sel_hi:[1,0]
v_pk_mul_f32 v[50:51], v[26:27], v[40:41] op_sel_hi:[1,0]
v_pk_fma_f32 v[22:23], v[22:23], v[40:41], v[44:45] op_sel:[1,1,0] op_sel_hi:[0,1,1] neg_lo:[1,0,0]
v_pk_fma_f32 v[28:29], v[28:29], v[40:41], v[46:47] op_sel:[1,1,0] op_sel_hi:[0,1,1] neg_lo:[1,0,0]
v_pk_fma_f32 v[24:25], v[24:25], v[40:41], v[48:49] op_sel:[1,1,0] op_sel_hi:[0,1,1] neg_lo:[1,0,0]
v_pk_fma_f32 v[26:27], v[26:27], v[40:41], v[50:51] op_sel:[1,1,0] op_sel_hi:[0,1,1] neg_lo:[1,0,0]
v_cvt_pk_bf16_f32 v54, v22, v23
ds_write_addtid_b32 v54 offset:16512
v_cvt_pk_bf16_f32 v55, v28, v29
ds_write_addtid_b32 v55 offset:18576
v_cvt_pk_bf16_f32 v56, v24, v25
ds_write_addtid_b32 v56 offset:20640
v_cvt_pk_bf16_f32 v57, v26, v27
ds_write_addtid_b32 v57 offset:22704
v_pk_mul_f32 v[44:45], v[22:23], v[40:41] op_sel_hi:[1,0]
v_pk_mul_f32 v[46:47], v[28:29], v[40:41] op_sel_hi:[1,0]
v_pk_mul_f32 v[48:49], v[24:25], v[40:41] op_sel_hi:[1,0]
v_pk_mul_f32 v[50:51], v[26:27], v[40:41] op_sel_hi:[1,0]
v_pk_fma_f32 v[22:23], v[22:23], v[40:41], v[44:45] op_sel:[1,1,0] op_sel_hi:[0,1,1] neg_lo:[1,0,0]
v_pk_fma_f32 v[28:29], v[28:29], v[40:41], v[46:47] op_sel:[1,1,0] op_sel_hi:[0,1,1] neg_lo:[1,0,0]
v_pk_fma_f32 v[24:25], v[24:25], v[40:41], v[48:49] op_sel:[1,1,0] op_sel_hi:[0,1,1] neg_lo:[1,0,0]
v_pk_fma_f32 v[26:27], v[26:27], v[40:41], v[50:51] op_sel:[1,1,0] op_sel_hi:[0,1,1] neg_lo:[1,0,0]
v_cvt_pk_bf16_f32 v54, v22, v23
ds_write_addtid_b32 v54 offset:24768
v_cvt_pk_bf16_f32 v55, v28, v29
ds_write_addtid_b32 v55 offset:26832
v_cvt_pk_bf16_f32 v56, v24, v25
ds_write_addtid_b32 v56 offset:28896
v_cvt_pk_bf16_f32 v57, v26, v27
ds_write_addtid_b32 v57 offset:30960
buffer_load_dwordx2 v[8:9], v3, s[32:35], 0 offen offset:0
buffer_load_dwordx2 v[10:11], v3, s[32:35], 0 offen offset:1024
v_pk_mul_f32 v[44:45], v[22:23], v[40:41] op_sel_hi:[1,0]
v_pk_mul_f32 v[46:47], v[28:29], v[40:41] op_sel_hi:[1,0]
v_pk_mul_f32 v[48:49], v[24:25], v[40:41] op_sel_hi:[1,0]
v_pk_mul_f32 v[50:51], v[26:27], v[40:41] op_sel_hi:[1,0]
v_pk_fma_f32 v[22:23], v[22:23], v[40:41], v[44:45] op_sel:[1,1,0] op_sel_hi:[0,1,1] neg_lo:[1,0,0]
v_pk_fma_f32 v[28:29], v[28:29], v[40:41], v[46:47] op_sel:[1,1,0] op_sel_hi:[0,1,1] neg_lo:[1,0,0]
v_pk_fma_f32 v[24:25], v[24:25], v[40:41], v[48:49] op_sel:[1,1,0] op_sel_hi:[0,1,1] neg_lo:[1,0,0]
v_pk_fma_f32 v[26:27], v[26:27], v[40:41], v[50:51] op_sel:[1,1,0] op_sel_hi:[0,1,1] neg_lo:[1,0,0]
v_cvt_pk_bf16_f32 v54, v22, v23
ds_write_addtid_b32 v54 offset:33024
v_cvt_pk_bf16_f32 v55, v28, v29
ds_write_addtid_b32 v55 offset:35088
v_cvt_pk_bf16_f32 v56, v24, v25
ds_write_addtid_b32 v56 offset:37152
v_cvt_pk_bf16_f32 v57, v26, v27
ds_write_addtid_b32 v57 offset:39216
v_pk_mul_f32 v[44:45], v[22:23], v[40:41] op_sel_hi:[1,0]
v_pk_mul_f32 v[46:47], v[28:29], v[40:41] op_sel_hi:[1,0]
v_pk_mul_f32 v[48:49], v[24:25], v[40:41] op_sel_hi:[1,0]
v_pk_mul_f32 v[50:51], v[26:27], v[40:41] op_sel_hi:[1,0]
v_pk_fma_f32 v[22:23], v[22:23], v[40:41], v[44:45] op_sel:[1,1,0] op_sel_hi:[0,1,1] neg_lo:[1,0,0]
v_pk_fma_f32 v[28:29], v[28:29], v[40:41], v[46:47] op_sel:[1,1,0] op_sel_hi:[0,1,1] neg_lo:[1,0,0]
v_pk_fma_f32 v[24:25], v[24:25], v[40:41], v[48:49] op_sel:[1,1,0] op_sel_hi:[0,1,1] neg_lo:[1,0,0]
v_pk_fma_f32 v[26:27], v[26:27], v[40:41], v[50:51] op_sel:[1,1,0] op_sel_hi:[0,1,1] neg_lo:[1,0,0]
v_cvt_pk_bf16_f32 v54, v22, v23
ds_write_addtid_b32 v54 offset:41280
v_cvt_pk_bf16_f32 v55, v28, v29
ds_write_addtid_b32 v55 offset:43344
v_cvt_pk_bf16_f32 v56, v24, v25
ds_write_addtid_b32 v56 offset:45408
v_cvt_pk_bf16_f32 v57, v26, v27
ds_write_addtid_b32 v57 offset:47472
v_pk_mul_f32 v[44:45], v[22:23], v[40:41] op_sel_hi:[1,0]
v_pk_mul_f32 v[46:47], v[28:29], v[40:41] op_sel_hi:[1,0]
v_pk_mul_f32 v[48:49], v[24:25], v[40:41] op_sel_hi:[1,0]
v_pk_mul_f32 v[50:51], v[26:27], v[40:41] op_sel_hi:[1,0]
v_pk_fma_f32 v[22:23], v[22:23], v[40:41], v[44:45] op_sel:[1,1,0] op_sel_hi:[0,1,1] neg_lo:[1,0,0]
v_pk_fma_f32 v[28:29], v[28:29], v[40:41], v[46:47] op_sel:[1,1,0] op_sel_hi:[0,1,1] neg_lo:[1,0,0]
v_pk_fma_f32 v[24:25], v[24:25], v[40:41], v[48:49] op_sel:[1,1,0] op_sel_hi:[0,1,1] neg_lo:[1,0,0]
v_pk_fma_f32 v[26:27], v[26:27], v[40:41], v[50:51] op_sel:[1,1,0] op_sel_hi:[0,1,1] neg_lo:[1,0,0]
v_cvt_pk_bf16_f32 v54, v22, v23
ds_write_addtid_b32 v54 offset:49536
v_cvt_pk_bf16_f32 v55, v28, v29
ds_write_addtid_b32 v55 offset:51600
v_cvt_pk_bf16_f32 v56, v24, v25
ds_write_addtid_b32 v56 offset:53664
v_cvt_pk_bf16_f32 v57, v26, v27
ds_write_addtid_b32 v57 offset:55728
v_pk_mul_f32 v[44:45], v[22:23], v[40:41] op_sel_hi:[1,0]
v_pk_mul_f32 v[46:47], v[28:29], v[40:41] op_sel_hi:[1,0]
v_pk_mul_f32 v[48:49], v[24:25], v[40:41] op_sel_hi:[1,0]
v_pk_mul_f32 v[50:51], v[26:27], v[40:41] op_sel_hi:[1,0]
v_pk_fma_f32 v[22:23], v[22:23], v[40:41], v[44:45] op_sel:[1,1,0] op_sel_hi:[0,1,1] neg_lo:[1,0,0]
v_pk_fma_f32 v[28:29], v[28:29], v[40:41], v[46:47] op_sel:[1,1,0] op_sel_hi:[0,1,1] neg_lo:[1,0,0]
v_pk_fma_f32 v[24:25], v[24:25], v[40:41], v[48:49] op_sel:[1,1,0] op_sel_hi:[0,1,1] neg_lo:[1,0,0]
v_pk_fma_f32 v[26:27], v[26:27], v[40:41], v[50:51] op_sel:[1,1,0] op_sel_hi:[0,1,1] neg_lo:[1,0,0]
v_cvt_pk_bf16_f32 v54, v22, v23
ds_write_addtid_b32 v54 offset:57792
v_cvt_pk_bf16_f32 v55, v28, v29
ds_write_addtid_b32 v55 offset:59856
v_cvt_pk_bf16_f32 v56, v24, v25
ds_write_addtid_b32 v56 offset:61920
v_cvt_pk_bf16_f32 v57, v26, v27
ds_write_addtid_b32 v57 offset:63984
buffer_load_dwordx2 v[12:13], v3, s[32:35], 0 offen offset:2048
buffer_load_dwordx2 v[14:15], v3, s[32:35], 0 offen offset:3072
s_add_u32 m0, s71, 59856
v_pk_mul_f32 v[44:45], v[60:61], v[30:31] op_sel_hi:[1,0]
v_pk_mul_f32 v[46:47], v[60:61], v[36:37] op_sel_hi:[1,0]
v_pk_mul_f32 v[48:49], v[60:61], v[38:39] op_sel_hi:[1,0]
v_pk_mul_f32 v[50:51], v[60:61], v[34:35] op_sel_hi:[1,0]
v_pk_fma_f32 v[62:63], v[60:61], v[30:31], v[44:45] op_sel:[1,1,0] op_sel_hi:[0,1,1] neg_hi:[1,0,0]
v_pk_fma_f32 v[64:65], v[60:61], v[36:37], v[46:47] op_sel:[1,1,0] op_sel_hi:[0,1,1] neg_hi:[1,0,0]
v_pk_fma_f32 v[68:69], v[60:61], v[38:39], v[48:49] op_sel:[1,1,0] op_sel_hi:[0,1,1] neg_hi:[1,0,0]
v_pk_fma_f32 v[76:77], v[60:61], v[34:35], v[50:51] op_sel:[1,1,0] op_sel_hi:[0,1,1] neg_hi:[1,0,0]
v_cvt_pk_bf16_f32 v54, v62, v63
ds_write_addtid_b32 v54 offset:8256
v_cvt_pk_bf16_f32 v55, v64, v65
ds_write_addtid_b32 v55 offset:10320
v_cvt_pk_bf16_f32 v56, v68, v69
ds_write_addtid_b32 v56 offset:14448
v_cvt_pk_bf16_f32 v57, v76, v77
ds_write_addtid_b32 v57 offset:22704
v_pk_mul_f32 v[44:45], v[62:63], v[36:37] op_sel_hi:[1,0]
v_pk_mul_f32 v[46:47], v[62:63], v[38:39] op_sel_hi:[1,0]
v_pk_mul_f32 v[48:49], v[64:65], v[38:39] op_sel_hi:[1,0]
v_pk_mul_f32 v[50:51], v[76:77], v[34:35] op_sel_hi:[1,0]
v_pk_fma_f32 v[66:67], v[62:63], v[36:37], v[44:45] op_sel:[1,1,0] op_sel_hi:[0,1,1] neg_hi:[1,0,0]
v_pk_fma_f32 v[70:71], v[62:63], v[38:39], v[46:47] op_sel:[1,1,0] op_sel_hi:[0,1,1] neg_hi:[1,0,0]
v_pk_fma_f32 v[72:73], v[64:65], v[38:39], v[48:49] op_sel:[1,1,0] op_sel_hi:[0,1,1] neg_hi:[1,0,0]
v_pk_fma_f32 v[86:87], v[76:77], v[34:35], v[50:51] op_sel:[1,1,0] op_sel_hi:[0,1,1] neg_hi:[1,0,0]
v_cvt_pk_bf16_f32 v54, v66, v67
ds_write_addtid_b32 v54 offset:12384
v_cvt_pk_bf16_f32 v55, v70, v71
ds_write_addtid_b32 v55 offset:16512
v_cvt_pk_bf16_f32 v56, v72, v73
ds_write_addtid_b32 v56 offset:18576
v_cvt_pk_bf16_f32 v57, v86, v87
ds_write_addtid_b32 v57 offset:33024
v_pk_mul_f32 v[44:45], v[66:67], v[38:39] op_sel_hi:[1,0]
v_pk_mul_f32 v[46:47], v[76:77], v[36:37] op_sel_hi:[1,0]
v_pk_mul_f32 v[48:49], v[76:77], v[38:39] op_sel_hi:[1,0]
v_pk_mul_f32 v[50:51], v[86:87], v[34:35] op_sel_hi:[1,0]
v_pk_fma_f32 v[74:75], v[66:67], v[38:39], v[44:45] op_sel:[1,1,0] op_sel_hi:[0,1,1] neg_hi:[1,0,0]
v_pk_fma_f32 v[78:79], v[76:77], v[36:37], v[46:47] op_sel:[1,1,0] op_sel_hi:[0,1,1] neg_hi:[1,0,0]
v_pk_fma_f32 v[80:81], v[76:77], v[38:39], v[48:49] op_sel:[1,1,0] op_sel_hi:[0,1,1] neg_hi:[1,0,0]
v_pk_fma_f32 v[92:93], v[86:87], v[34:35], v[50:51] op_sel:[1,1,0] op_sel_hi:[0,1,1] neg_hi:[1,0,0]
v_cvt_pk_bf16_f32 v54, v74, v75
ds_write_addtid_b32 v54 offset:20640
v_cvt_pk_bf16_f32 v55, v78, v79
ds_write_addtid_b32 v55 offset:24768
v_cvt_pk_bf16_f32 v56, v80, v81
ds_write_addtid_b32 v56 offset:26832
v_cvt_pk_bf16_f32 v57, v92, v93
ds_write_addtid_b32 v57 offset:39216
v_pk_mul_f32 v[44:45], v[78:79], v[38:39] op_sel_hi:[1,0]
v_pk_mul_f32 v[46:47], v[76:77], v[32:33] op_sel_hi:[1,0]
v_pk_mul_f32 v[48:49], v[86:87], v[38:39] op_sel_hi:[1,0]
v_pk_mul_f32 v[50:51], v[92:93], v[34:35] op_sel_hi:[1,0]
v_pk_fma_f32 v[82:83], v[78:79], v[38:39], v[44:45] op_sel:[1,1,0] op_sel_hi:[0,1,1] neg_hi:[1,0,0]
v_pk_fma_f32 v[84:85], v[76:77], v[32:33], v[46:47] op_sel:[1,1,0] op_sel_hi:[0,1,1] neg_hi:[1,0,0]
v_pk_fma_f32 v[88:89], v[86:87], v[38:39], v[48:49] op_sel:[1,1,0] op_sel_hi:[0,1,1] neg_hi:[1,0,0]
v_pk_fma_f32 v[98:99], v[92:93], v[34:35], v[50:51] op_sel:[1,1,0] op_sel_hi:[0,1,1] neg_hi:[1,0,0]
v_cvt_pk_bf16_f32 v54, v82, v83
ds_write_addtid_b32 v54 offset:28896
v_cvt_pk_bf16_f32 v55, v84, v85
ds_write_addtid_b32 v55 offset:30960
v_cvt_pk_bf16_f32 v56, v88, v89
ds_write_addtid_b32 v56 offset:35088
v_cvt_pk_bf16_f32 v57, v98, v99
ds_write_addtid_b32 v57 offset:45408
v_pk_mul_f32 v[44:45], v[86:87], v[32:33] op_sel_hi:[1,0]
v_pk_mul_f32 v[46:47], v[92:93], v[38:39] op_sel_hi:[1,0]
v_pk_mul_f32 v[48:49], v[92:93], v[32:33] op_sel_hi:[1,0]
v_pk_mul_f32 v[50:51], v[98:99], v[34:35] op_sel_hi:[1,0]
v_pk_fma_f32 v[90:91], v[86:87], v[32:33], v[44:45] op_sel:[1,1,0] op_sel_hi:[0,1,1] neg_hi:[1,0,0]
v_pk_fma_f32 v[94:95], v[92:93], v[38:39], v[46:47] op_sel:[1,1,0] op_sel_hi:[0,1,1] neg_hi:[1,0,0]
v_pk_fma_f32 v[96:97], v[92:93], v[32:33], v[48:49] op_sel:[1,1,0] op_sel_hi:[0,1,1] neg_hi:[1,0,0]
v_pk_fma_f32 v[102:103], v[98:99], v[34:35], v[50:51] op_sel:[1,1,0] op_sel_hi:[0,1,1] neg_hi:[1,0,0]
v_cvt_pk_bf16_f32 v54, v90, v91
ds_write_addtid_b32 v54 offset:37152
v_cvt_pk_bf16_f32 v55, v94, v95
ds_write_addtid_b32 v55 offset:41280
v_cvt_pk_bf16_f32 v56, v96, v97
ds_write_addtid_b32 v56 offset:43344
v_cvt_pk_bf16_f32 v57, v102, v103
ds_write_addtid_b32 v57 offset:49536
v_pk_mul_f32 v[44:45], v[98:99], v[32:33] op_sel_hi:[1,0]
v_pk_mul_f32 v[46:47], v[102:103], v[32:33] op_sel_hi:[1,0]
v_pk_mul_f32 v[48:49], v[102:103], v[34:35] op_sel_hi:[1,0]
v_pk_fma_f32 v[100:101], v[98:99], v[32:33], v[44:45] op_sel:[1,1,0] op_sel_hi:[0,1,1] neg_hi:[1,0,0]
v_pk_fma_f32 v[104:105], v[102:103], v[32:33], v[46:47] op_sel:[1,1,0] op_sel_hi:[0,1,1] neg_hi:[1,0,0]
v_pk_fma_f32 v[106:107], v[102:103], v[34:35], v[48:49] op_sel:[1,1,0] op_sel_hi:[0,1,1] neg_hi:[1,0,0]
v_cvt_pk_bf16_f32 v54, v100, v101
ds_write_addtid_b32 v54 offset:47472
v_cvt_pk_bf16_f32 v55, v104, v105
ds_write_addtid_b32 v55 offset:51600
v_cvt_pk_bf16_f32 v56, v106, v107
ds_write_addtid_b32 v56 offset:53664
v_pk_mul_f32 v[44:45], v[106:107], v[32:33] op_sel_hi:[1,0]
v_pk_mul_f32 v[46:47], v[106:107], v[34:35] op_sel_hi:[1,0]
v_pk_fma_f32 v[108:109], v[106:107], v[32:33], v[44:45] op_sel:[1,1,0] op_sel_hi:[0,1,1] neg_hi:[1,0,0]
v_pk_fma_f32 v[110:111], v[106:107], v[34:35], v[46:47] op_sel:[1,1,0] op_sel_hi:[0,1,1] neg_hi:[1,0,0]
v_cvt_pk_bf16_f32 v57, v108, v109
ds_write_addtid_b32 v57 offset:55728
v_cvt_pk_bf16_f32 v54, v110, v111
ds_write_addtid_b32 v54 offset:57792
v_pk_mul_f32 v[44:45], v[110:111], v[32:33] op_sel_hi:[1,0]
v_pk_fma_f32 v[112:113], v[110:111], v[32:33], v[44:45] op_sel:[1,1,0] op_sel_hi:[0,1,1] neg_hi:[1,0,0]
v_cvt_pk_bf16_f32 v55, v112, v113
ds_write_addtid_b32 v55 offset:59856
v_cvt_pk_bf16_f32 v56, v60, v61
ds_write_addtid_b32 v56 offset:6192
v_and_b32 v21, 31, v1
v_mov_b32 v22, 32
s_mov_b32 s72, 0x555b4a4a
v_bfe_u32 v23, s72, v21, 1
v_lshl_or_b32 v22, v23, 0, v22
s_mov_b32 s72, 0xa6637c8c
v_bfe_u32 v23, s72, v21, 1
v_lshl_or_b32 v22, v23, 1, v22
s_mov_b32 s72, 0x77c8f00
v_bfe_u32 v23, s72, v21, 1
v_lshl_or_b32 v22, v23, 2, v22
s_mov_b32 s72, 0xc870f0f0
v_bfe_u32 v23, s72, v21, 1
v_lshl_or_b32 v22, v23, 3, v22
s_mov_b32 s72, 0xff8f0000
v_bfe_u32 v23, s72, v21, 1
v_lshl_or_b32 v22, v23, 4, v22
v_lshrrev_b32 v24, 5, v1
s_lshl_b32 s72, s66, 9
v_lshl_add_u32 v23, v24, 4, s72
s_movk_i32 s73, 2064
v_mad_u32_u24 v22, v22, s73, v23
v_mad_u32_u24 v23, v21, s73, v23
s_waitcnt lgkmcnt(0)
s_barrier
s_cmp_gt_u32 s70, 3
s_cbranch_scc1 L_B1
ds_read_b128 v[64:67], v22 offset:0
ds_read_b128 v[68:71], v23 offset:0
ds_read_b128 v[72:75], v22 offset:32
ds_read_b128 v[76:79], v23 offset:32
ds_read_b128 v[80:83], v22 offset:64
ds_read_b128 v[84:87], v23 offset:64
ds_read_b128 v[88:91], v22 offset:96
ds_read_b128 v[92:95], v23 offset:96
ds_read_b128 v[96:99], v22 offset:128
ds_read_b128 v[100:103], v23 offset:128
s_waitcnt lgkmcnt(8)
v_mfma_f32_32x32x16_bf16 v[32:47], v[64:67], v[68:71], 0
ds_read_b128 v[104:107], v22 offset:160
ds_read_b128 v[108:111], v23 offset:160
s_waitcnt lgkmcnt(8)
v_mfma_f32_32x32x16_bf16 v[32:47], v[72:75], v[76:79], v[32:47]
ds_read_b128 v[112:115], v22 offset:192
ds_read_b128 v[116:119], v23 offset:192
s_waitcnt lgkmcnt(8)
v_mfma_f32_32x32x16_bf16 v[32:47], v[80:83], v[84:87], v[32:47]
ds_read_b128 v[120:123], v22 offset:224
ds_read_b128 v[124:127], v23 offset:224
s_waitcnt lgkmcnt(8)
v_mfma_f32_32x32x16_bf16 v[32:47], v[88:91], v[92:95], v[32:47]
ds_read_b128 v[128:131], v22 offset:256
ds_read_b128 v[132:135], v23 offset:256
s_waitcnt lgkmcnt(8)
v_mfma_f32_32x32x16_bf16 v[32:47], v[96:99], v[100:103], v[32:47]
ds_read_b128 v[136:139], v22 offset:288
ds_read_b128 v[140:143], v23 offset:288
s_waitcnt lgkmcnt(8)
v_mfma_f32_32x32x16_bf16 v[32:47], v[104:107], v[108:111], v[32:47]
ds_read_b128 v[144:147], v22 offset:320
ds_read_b128 v[148:151], v23 offset:320
s_waitcnt lgkmcnt(8)
v_mfma_f32_32x32x16_bf16 v[32:47], v[112:115], v[116:119], v[32:47]
ds_read_b128 v[152:155], v22 offset:352
ds_read_b128 v[156:159], v23 offset:352
s_waitcnt lgkmcnt(8)
v_mfma_f32_32x32x16_bf16 v[32:47], v[120:123], v[124:127], v[32:47]
ds_read_b128 v[160:163], v22 offset:384
ds_read_b128 v[164:167], v23 offset:384
s_waitcnt lgkmcnt(8)
v_mfma_f32_32x32x16_bf16 v[32:47], v[128:131], v[132:135], v[32:47]
ds_read_b128 v[168:171], v22 offset:416
ds_read_b128 v[172:175], v23 offset:416
s_waitcnt lgkmcnt(8)
v_mfma_f32_32x32x16_bf16 v[32:47], v[136:139], v[140:143], v[32:47]
ds_read_b128 v[176:179], v22 offset:448
ds_read_b128 v[180:183], v23 offset:448
s_waitcnt lgkmcnt(8)
v_mfma_f32_32x32x16_bf16 v[32:47], v[144:147], v[148:151], v[32:47]
ds_read_b128 v[184:187], v22 offset:480
ds_read_b128 v[188:191], v23 offset:480
s_waitcnt lgkmcnt(8)
v_mfma_f32_32x32x16_bf16 v[32:47], v[152:155], v[156:159], v[32:47]
s_waitcnt lgkmcnt(6)
v_mfma_f32_32x32x16_bf16 v[32:47], v[160:163], v[164:167], v[32:47]
s_waitcnt lgkmcnt(4)
v_mfma_f32_32x32x16_bf16 v[32:47], v[168:171], v[172:175], v[32:47]
s_waitcnt lgkmcnt(2)
v_mfma_f32_32x32x16_bf16 v[32:47], v[176:179], v[180:183], v[32:47]
s_waitcnt lgkmcnt(0)
v_mfma_f32_32x32x16_bf16 v[32:47], v[184:187], v[188:191], v[32:47]
s_branch L_B6
L_B1:
s_mov_b32 s60, s6
s_mov_b32 s61, s7
s_mov_b32 s62, 0x180000
s_mov_b32 s63, 0x20000
s_and_b32 s72, s2, 0x78
s_lshl1_add_u32 s72, s66, s72
s_mul_i32 s72, s72, 0x3000
s_and_b32 s73, s2, 1
s_lshl_b32 s73, s73, 9
s_add_u32 s72, s72, s73
v_lshrrev_b32 v18, 2, v1
v_mul_u32_u24 v18, 0xc00, v18
v_and_b32 v19, 3, v1
v_lshl_add_u32 v18, v19, 7, v18
s_mov_b32 exec_hi, 0
buffer_load_dword v200, v18, s[60:63], s72 offen
s_mov_b32 exec_hi, -1
L_B6:
s_cmp_gt_u32 s70, 3
s_barrier
s_cbranch_scc1 L_B2
s_mul_i32 s72, s66, 4608
v_lshl_add_u32 v22, v1, 4, s72
v_lshl_add_u32 v25, v21, 4, s72
v_mul_u32_u24 v23, 0x400, v24
v_sub_u32 v23, v25, v23
v_mov_b32 v26, 0
v_mov_b32 v27, 0
v_mov_b32 v28, 0
v_mov_b32 v29, 0
ds_write_b128 v25, v[26:29]
s_mov_b32 s74, 0xaaaaaaaa
s_mov_b32 s75, 0
s_mov_b32 s76, 0
s_mov_b32 s77, -1
s_mov_b32 s78, 0xaaaaaaaa
s_mov_b32 s79, 0xaaaaaaaa
s_mov_b64 exec, 1
v_add_f32 v32, s58, v32
s_mov_b64 exec, -1
v_cvt_pk_bf16_f32 v48, v39, v38
v_cvt_pk_bf16_f32 v49, v37, v36
v_cvt_pk_bf16_f32 v50, v35, v34
v_cvt_pk_bf16_f32 v51, v33, v32
ds_write_b128 v22, v[48:51] offset:512
v_cndmask_b32 v30, v41, v42, s[74:75]
v_cndmask_b32 v31, v42, v41, s[76:77]
v_cvt_pk_bf16_f32 v52, v42, v42
v_cvt_pk_bf16_f32 v53, v31, v30
v_cvt_pk_bf16_f32 v54, v41, v40
v_cvt_pk_bf16_f32 v55, v40, v40
ds_write_b128 v23, v[52:55] offset:2560
v_cndmask_b32 v30, v44, v45, s[74:75]
v_cndmask_b32 v31, v45, v44, s[76:77]
v_cvt_pk_bf16_f32 v56, v45, v45
v_cvt_pk_bf16_f32 v57, v31, v30
v_cvt_pk_bf16_f32 v58, v44, v43
v_cvt_pk_bf16_f32 v59, v43, v43
ds_write_b128 v23, v[56:59] offset:3072
v_cndmask_b32 v30, v46, v47, s[78:79]
v_cvt_pk_bf16_f32 v60, v47, v47
v_cvt_pk_bf16_f32 v61, v47, v30
v_cvt_pk_bf16_f32 v62, v46, v46
v_cvt_pk_bf16_f32 v63, v46, v46
ds_write_b128 v22, v[60:63] offset:3584
s_waitcnt vmcnt(0)
L_B2:
v_lshlrev_b32 v18, 3, v0
v_add_u32 v18, 121808, v18
s_mov_b32 s72, 0x05040100
s_mov_b32 s73, 0x07060302
s_waitcnt vmcnt(1)
v_mov_b32_dpp v16, v14 wave_shr:1 row_mask:0xf bank_mask:0xf
v_mov_b32_dpp v17, v15 wave_shr:1 row_mask:0xf bank_mask:0xf
v_perm_b32 v64, v10, v8, s72
v_perm_b32 v65, v14, v12, s72
v_perm_b32 v66, v8, v16, s72
v_perm_b32 v67, v12, v10, s72
ds_write_b64 v18, v[64:65] offset:0
ds_write_b64 v18, v[66:67] offset:4160
v_perm_b32 v68, v10, v8, s73
v_perm_b32 v69, v14, v12, s73
v_perm_b32 v70, v8, v16, s73
v_perm_b32 v71, v12, v10, s73
ds_write_b64 v18, v[68:69] offset:8320
ds_write_b64 v18, v[70:71] offset:12480
v_perm_b32 v72, v11, v9, s72
v_perm_b32 v73, v15, v13, s72
v_perm_b32 v74, v9, v17, s72
v_perm_b32 v75, v13, v11, s72
ds_write_b64 v18, v[72:73] offset:16640
ds_write_b64 v18, v[74:75] offset:20800
v_perm_b32 v76, v11, v9, s73
v_perm_b32 v77, v15, v13, s73
v_perm_b32 v78, v9, v17, s73
v_perm_b32 v79, v13, v11, s73
ds_write_b64 v18, v[76:77] offset:24960
ds_write_b64 v18, v[78:79] offset:29120
v_and_b32 v21, 15, v1
v_lshrrev_b32 v24, 4, v1
v_lshl_add_u32 v22, v24, 3, v21
v_and_b32 v23, 1, v22
v_sub_u32 v23, 1, v23
v_add_u32 v22, 2, v22
v_lshrrev_b32 v22, 1, v22
s_mul_i32 s74, s66, 8320
s_add_u32 s74, s74, 121776
v_lshl_add_u32 v22, v22, 2, s74
s_movk_i32 s75, 4160
v_mad_u32_u24 v4, v23, s75, v22
v_add_u32 v5, 0x400, v4
v_add_u32 v6, 0x800, v4
v_add_u32 v7, 0xc00, v4
v_lshlrev_b32 v22, 1, v21
v_sub_u32 v22, v22, v24
s_mul_i32 s74, s66, 4608
s_add_u32 s74, s74, 80
v_lshl_add_u32 v8, v22, 4, s74
v_lshlrev_b32 v9, 5, v21
v_lshl_add_u32 v9, v24, 3, v9
s_lshl_b32 s74, s66, 12
v_add_u32 v9, s74, v9
s_cmp_gt_u32 s70, 3
s_waitcnt lgkmcnt(0)
s_barrier
s_cbranch_scc1 L_B4
ds_read_b128 v[96:99], v8 offset:448
ds_read2_b32 v[64:65], v4 offset0:0 offset1:1
ds_read2_b32 v[66:67], v4 offset0:2 offset1:3
ds_read_b128 v[100:103], v8 offset:960
ds_read2_b32 v[68:69], v4 offset0:128 offset1:129
ds_read2_b32 v[70:71], v4 offset0:130 offset1:131
ds_read_b128 v[104:107], v8 offset:1472
ds_read2_b32 v[72:73], v5 offset0:0 offset1:1
ds_read2_b32 v[74:75], v5 offset0:2 offset1:3
ds_read_b128 v[108:111], v8 offset:1984
ds_read2_b32 v[76:77], v5 offset0:128 offset1:129
ds_read2_b32 v[78:79], v5 offset0:130 offset1:131
ds_read_b128 v[112:115], v8 offset:2496
ds_read_b128 v[116:119], v8 offset:3008
ds_read_b128 v[120:123], v8 offset:3520
ds_read_b128 v[124:127], v8 offset:4032
s_waitcnt lgkmcnt(0)
v_mfma_f32_16x16x32_bf16 v[16:19], v[64:67], v[96:99], 0
ds_read_b128 v[160:163], v8 offset:384
v_mfma_f32_16x16x32_bf16 v[20:23], v[64:67], v[100:103], 0
ds_read2_b32 v[128:129], v4 offset0:16 offset1:17
v_mfma_f32_16x16x32_bf16 v[24:27], v[64:67], v[104:107], 0
ds_read2_b32 v[130:131], v4 offset0:18 offset1:19
v_mfma_f32_16x16x32_bf16 v[28:31], v[64:67], v[108:111], 0
ds_read_b128 v[164:167], v8 offset:896
v_mfma_f32_16x16x32_bf16 v[32:35], v[64:67], v[112:115], 0
ds_read2_b32 v[132:133], v4 offset0:144 offset1:145
v_mfma_f32_16x16x32_bf16 v[36:39], v[64:67], v[116:119], 0
ds_read2_b32 v[134:135], v4 offset0:146 offset1:147
v_mfma_f32_16x16x32_bf16 v[40:43], v[64:67], v[120:123], 0
ds_read_b128 v[168:171], v8 offset:1408
v_mfma_f32_16x16x32_bf16 v[44:47], v[64:67], v[124:127], 0
ds_read2_b32 v[136:137], v5 offset0:16 offset1:17
v_mfma_f32_16x16x32_bf16 v[20:23], v[68:71], v[96:99], v[20:23]
ds_read2_b32 v[138:139], v5 offset0:18 offset1:19
v_mfma_f32_16x16x32_bf16 v[24:27], v[68:71], v[100:103], v[24:27]
ds_read_b128 v[172:175], v8 offset:1920
v_mfma_f32_16x16x32_bf16 v[28:31], v[68:71], v[104:107], v[28:31]
ds_read2_b32 v[140:141], v5 offset0:144 offset1:145
v_mfma_f32_16x16x32_bf16 v[32:35], v[68:71], v[108:111], v[32:35]
ds_read2_b32 v[142:143], v5 offset0:146 offset1:147
v_mfma_f32_16x16x32_bf16 v[36:39], v[68:71], v[112:115], v[36:39]
ds_read_b128 v[176:179], v8 offset:2432
v_mfma_f32_16x16x32_bf16 v[40:43], v[68:71], v[116:119], v[40:43]
ds_read_b128 v[180:183], v8 offset:2944
v_mfma_f32_16x16x32_bf16 v[44:47], v[68:71], v[120:123], v[44:47]
ds_read_b128 v[184:187], v8 offset:3456
v_mfma_f32_16x16x32_bf16 v[24:27], v[72:75], v[96:99], v[24:27]
ds_read_b128 v[188:191], v8 offset:3968
v_mfma_f32_16x16x32_bf16 v[28:31], v[72:75], v[100:103], v[28:31]
v_mfma_f32_16x16x32_bf16 v[32:35], v[72:75], v[104:107], v[32:35]
v_mfma_f32_16x16x32_bf16 v[36:39], v[72:75], v[108:111], v[36:39]
v_mfma_f32_16x16x32_bf16 v[40:43], v[72:75], v[112:115], v[40:43]
v_mfma_f32_16x16x32_bf16 v[44:47], v[72:75], v[116:119], v[44:47]
v_mfma_f32_16x16x32_bf16 v[28:31], v[76:79], v[96:99], v[28:31]
v_mfma_f32_16x16x32_bf16 v[32:35], v[76:79], v[100:103], v[32:35]
v_mfma_f32_16x16x32_bf16 v[36:39], v[76:79], v[104:107], v[36:39]
v_mfma_f32_16x16x32_bf16 v[40:43], v[76:79], v[108:111], v[40:43]
v_mfma_f32_16x16x32_bf16 v[44:47], v[76:79], v[112:115], v[44:47]
s_waitcnt lgkmcnt(0)
v_mfma_f32_16x16x32_bf16 v[16:19], v[128:131], v[160:163], v[16:19]
ds_read_b128 v[96:99], v8 offset:320
v_mfma_f32_16x16x32_bf16 v[20:23], v[128:131], v[164:167], v[20:23]
ds_read2_b32 v[64:65], v4 offset0:32 offset1:33
v_mfma_f32_16x16x32_bf16 v[24:27], v[128:131], v[168:171], v[24:27]
ds_read2_b32 v[66:67], v4 offset0:34 offset1:35
v_mfma_f32_16x16x32_bf16 v[28:31], v[128:131], v[172:175], v[28:31]
ds_read_b128 v[100:103], v8 offset:832
v_mfma_f32_16x16x32_bf16 v[32:35], v[128:131], v[176:179], v[32:35]
ds_read2_b32 v[68:69], v4 offset0:160 offset1:161
v_mfma_f32_16x16x32_bf16 v[36:39], v[128:131], v[180:183], v[36:39]
ds_read2_b32 v[70:71], v4 offset0:162 offset1:163
v_mfma_f32_16x16x32_bf16 v[40:43], v[128:131], v[184:187], v[40:43]
ds_read_b128 v[104:107], v8 offset:1344
v_mfma_f32_16x16x32_bf16 v[44:47], v[128:131], v[188:191], v[44:47]
ds_read2_b32 v[72:73], v5 offset0:32 offset1:33
v_mfma_f32_16x16x32_bf16 v[20:23], v[132:135], v[160:163], v[20:23]
ds_read2_b32 v[74:75], v5 offset0:34 offset1:35
v_mfma_f32_16x16x32_bf16 v[24:27], v[132:135], v[164:167], v[24:27]
ds_read_b128 v[108:111], v8 offset:1856
v_mfma_f32_16x16x32_bf16 v[28:31], v[132:135], v[168:171], v[28:31]
ds_read2_b32 v[76:77], v5 offset0:160 offset1:161
v_mfma_f32_16x16x32_bf16 v[32:35], v[132:135], v[172:175], v[32:35]
ds_read2_b32 v[78:79], v5 offset0:162 offset1:163
v_mfma_f32_16x16x32_bf16 v[36:39], v[132:135], v[176:179], v[36:39]
ds_read_b128 v[112:115], v8 offset:2368
v_mfma_f32_16x16x32_bf16 v[40:43], v[132:135], v[180:183], v[40:43]
ds_read_b128 v[116:119], v8 offset:2880
v_mfma_f32_16x16x32_bf16 v[44:47], v[132:135], v[184:187], v[44:47]
ds_read_b128 v[120:123], v8 offset:3392
v_mfma_f32_16x16x32_bf16 v[24:27], v[136:139], v[160:163], v[24:27]
ds_read_b128 v[124:127], v8 offset:3904
v_mfma_f32_16x16x32_bf16 v[28:31], v[136:139], v[164:167], v[28:31]
v_mfma_f32_16x16x32_bf16 v[32:35], v[136:139], v[168:171], v[32:35]
v_mfma_f32_16x16x32_bf16 v[36:39], v[136:139], v[172:175], v[36:39]
v_mfma_f32_16x16x32_bf16 v[40:43], v[136:139], v[176:179], v[40:43]
v_mfma_f32_16x16x32_bf16 v[44:47], v[136:139], v[180:183], v[44:47]
v_mfma_f32_16x16x32_bf16 v[28:31], v[140:143], v[160:163], v[28:31]
v_mfma_f32_16x16x32_bf16 v[32:35], v[140:143], v[164:167], v[32:35]
v_mfma_f32_16x16x32_bf16 v[36:39], v[140:143], v[168:171], v[36:39]
v_mfma_f32_16x16x32_bf16 v[40:43], v[140:143], v[172:175], v[40:43]
v_mfma_f32_16x16x32_bf16 v[44:47], v[140:143], v[176:179], v[44:47]
s_waitcnt lgkmcnt(0)
v_mfma_f32_16x16x32_bf16 v[16:19], v[64:67], v[96:99], v[16:19]
ds_read_b128 v[160:163], v8 offset:256
v_mfma_f32_16x16x32_bf16 v[20:23], v[64:67], v[100:103], v[20:23]
ds_read2_b32 v[128:129], v4 offset0:48 offset1:49
v_mfma_f32_16x16x32_bf16 v[24:27], v[64:67], v[104:107], v[24:27]
ds_read2_b32 v[130:131], v4 offset0:50 offset1:51
v_mfma_f32_16x16x32_bf16 v[28:31], v[64:67], v[108:111], v[28:31]
ds_read_b128 v[164:167], v8 offset:768
v_mfma_f32_16x16x32_bf16 v[32:35], v[64:67], v[112:115], v[32:35]
ds_read2_b32 v[132:133], v4 offset0:176 offset1:177
v_mfma_f32_16x16x32_bf16 v[36:39], v[64:67], v[116:119], v[36:39]
ds_read2_b32 v[134:135], v4 offset0:178 offset1:179
v_mfma_f32_16x16x32_bf16 v[40:43], v[64:67], v[120:123], v[40:43]
ds_read_b128 v[168:171], v8 offset:1280
v_mfma_f32_16x16x32_bf16 v[44:47], v[64:67], v[124:127], v[44:47]
ds_read2_b32 v[136:137], v5 offset0:48 offset1:49
v_mfma_f32_16x16x32_bf16 v[20:23], v[68:71], v[96:99], v[20:23]
ds_read2_b32 v[138:139], v5 offset0:50 offset1:51
v_mfma_f32_16x16x32_bf16 v[24:27], v[68:71], v[100:103], v[24:27]
ds_read_b128 v[172:175], v8 offset:1792
v_mfma_f32_16x16x32_bf16 v[28:31], v[68:71], v[104:107], v[28:31]
ds_read2_b32 v[140:141], v5 offset0:176 offset1:177
v_mfma_f32_16x16x32_bf16 v[32:35], v[68:71], v[108:111], v[32:35]
ds_read2_b32 v[142:143], v5 offset0:178 offset1:179
v_mfma_f32_16x16x32_bf16 v[36:39], v[68:71], v[112:115], v[36:39]
ds_read_b128 v[176:179], v8 offset:2304
v_mfma_f32_16x16x32_bf16 v[40:43], v[68:71], v[116:119], v[40:43]
ds_read_b128 v[180:183], v8 offset:2816
v_mfma_f32_16x16x32_bf16 v[44:47], v[68:71], v[120:123], v[44:47]
ds_read_b128 v[184:187], v8 offset:3328
v_mfma_f32_16x16x32_bf16 v[24:27], v[72:75], v[96:99], v[24:27]
ds_read_b128 v[188:191], v8 offset:3840
v_mfma_f32_16x16x32_bf16 v[28:31], v[72:75], v[100:103], v[28:31]
v_mfma_f32_16x16x32_bf16 v[32:35], v[72:75], v[104:107], v[32:35]
v_mfma_f32_16x16x32_bf16 v[36:39], v[72:75], v[108:111], v[36:39]
v_mfma_f32_16x16x32_bf16 v[40:43], v[72:75], v[112:115], v[40:43]
v_mfma_f32_16x16x32_bf16 v[44:47], v[72:75], v[116:119], v[44:47]
v_mfma_f32_16x16x32_bf16 v[28:31], v[76:79], v[96:99], v[28:31]
v_mfma_f32_16x16x32_bf16 v[32:35], v[76:79], v[100:103], v[32:35]
v_mfma_f32_16x16x32_bf16 v[36:39], v[76:79], v[104:107], v[36:39]
v_mfma_f32_16x16x32_bf16 v[40:43], v[76:79], v[108:111], v[40:43]
v_mfma_f32_16x16x32_bf16 v[44:47], v[76:79], v[112:115], v[44:47]
s_waitcnt lgkmcnt(0)
v_mfma_f32_16x16x32_bf16 v[16:19], v[128:131], v[160:163], v[16:19]
ds_read_b128 v[96:99], v8 offset:192
v_mfma_f32_16x16x32_bf16 v[20:23], v[128:131], v[164:167], v[20:23]
ds_read2_b32 v[64:65], v4 offset0:64 offset1:65
v_mfma_f32_16x16x32_bf16 v[24:27], v[128:131], v[168:171], v[24:27]
ds_read2_b32 v[66:67], v4 offset0:66 offset1:67
v_mfma_f32_16x16x32_bf16 v[28:31], v[128:131], v[172:175], v[28:31]
ds_read_b128 v[100:103], v8 offset:704
v_mfma_f32_16x16x32_bf16 v[32:35], v[128:131], v[176:179], v[32:35]
ds_read2_b32 v[68:69], v4 offset0:192 offset1:193
v_mfma_f32_16x16x32_bf16 v[36:39], v[128:131], v[180:183], v[36:39]
ds_read2_b32 v[70:71], v4 offset0:194 offset1:195
v_mfma_f32_16x16x32_bf16 v[40:43], v[128:131], v[184:187], v[40:43]
ds_read_b128 v[104:107], v8 offset:1216
v_mfma_f32_16x16x32_bf16 v[44:47], v[128:131], v[188:191], v[44:47]
ds_read2_b32 v[72:73], v5 offset0:64 offset1:65
v_mfma_f32_16x16x32_bf16 v[20:23], v[132:135], v[160:163], v[20:23]
ds_read2_b32 v[74:75], v5 offset0:66 offset1:67
v_mfma_f32_16x16x32_bf16 v[24:27], v[132:135], v[164:167], v[24:27]
ds_read_b128 v[108:111], v8 offset:1728
v_mfma_f32_16x16x32_bf16 v[28:31], v[132:135], v[168:171], v[28:31]
ds_read2_b32 v[76:77], v5 offset0:192 offset1:193
v_mfma_f32_16x16x32_bf16 v[32:35], v[132:135], v[172:175], v[32:35]
ds_read2_b32 v[78:79], v5 offset0:194 offset1:195
v_mfma_f32_16x16x32_bf16 v[36:39], v[132:135], v[176:179], v[36:39]
ds_read_b128 v[112:115], v8 offset:2240
v_mfma_f32_16x16x32_bf16 v[40:43], v[132:135], v[180:183], v[40:43]
ds_read_b128 v[116:119], v8 offset:2752
v_mfma_f32_16x16x32_bf16 v[44:47], v[132:135], v[184:187], v[44:47]
ds_read_b128 v[120:123], v8 offset:3264
v_mfma_f32_16x16x32_bf16 v[24:27], v[136:139], v[160:163], v[24:27]
ds_read_b128 v[124:127], v8 offset:3776
v_mfma_f32_16x16x32_bf16 v[28:31], v[136:139], v[164:167], v[28:31]
v_mfma_f32_16x16x32_bf16 v[32:35], v[136:139], v[168:171], v[32:35]
v_mfma_f32_16x16x32_bf16 v[36:39], v[136:139], v[172:175], v[36:39]
v_mfma_f32_16x16x32_bf16 v[40:43], v[136:139], v[176:179], v[40:43]
v_mfma_f32_16x16x32_bf16 v[44:47], v[136:139], v[180:183], v[44:47]
v_mfma_f32_16x16x32_bf16 v[28:31], v[140:143], v[160:163], v[28:31]
v_mfma_f32_16x16x32_bf16 v[32:35], v[140:143], v[164:167], v[32:35]
v_mfma_f32_16x16x32_bf16 v[36:39], v[140:143], v[168:171], v[36:39]
v_mfma_f32_16x16x32_bf16 v[40:43], v[140:143], v[172:175], v[40:43]
v_mfma_f32_16x16x32_bf16 v[44:47], v[140:143], v[176:179], v[44:47]
s_waitcnt lgkmcnt(0)
v_mfma_f32_16x16x32_bf16 v[16:19], v[64:67], v[96:99], v[16:19]
ds_read_b128 v[160:163], v8 offset:128
v_mfma_f32_16x16x32_bf16 v[20:23], v[64:67], v[100:103], v[20:23]
ds_read2_b32 v[128:129], v4 offset0:80 offset1:81
v_mfma_f32_16x16x32_bf16 v[24:27], v[64:67], v[104:107], v[24:27]
ds_read2_b32 v[130:131], v4 offset0:82 offset1:83
v_mfma_f32_16x16x32_bf16 v[28:31], v[64:67], v[108:111], v[28:31]
ds_read_b128 v[164:167], v8 offset:640
v_mfma_f32_16x16x32_bf16 v[32:35], v[64:67], v[112:115], v[32:35]
ds_read2_b32 v[132:133], v4 offset0:208 offset1:209
v_mfma_f32_16x16x32_bf16 v[36:39], v[64:67], v[116:119], v[36:39]
ds_read2_b32 v[134:135], v4 offset0:210 offset1:211
v_mfma_f32_16x16x32_bf16 v[40:43], v[64:67], v[120:123], v[40:43]
ds_read_b128 v[168:171], v8 offset:1152
v_mfma_f32_16x16x32_bf16 v[44:47], v[64:67], v[124:127], v[44:47]
ds_read2_b32 v[136:137], v5 offset0:80 offset1:81
v_mfma_f32_16x16x32_bf16 v[20:23], v[68:71], v[96:99], v[20:23]
ds_read2_b32 v[138:139], v5 offset0:82 offset1:83
v_mfma_f32_16x16x32_bf16 v[24:27], v[68:71], v[100:103], v[24:27]
ds_read_b128 v[172:175], v8 offset:1664
v_mfma_f32_16x16x32_bf16 v[28:31], v[68:71], v[104:107], v[28:31]
ds_read2_b32 v[140:141], v5 offset0:208 offset1:209
v_mfma_f32_16x16x32_bf16 v[32:35], v[68:71], v[108:111], v[32:35]
ds_read2_b32 v[142:143], v5 offset0:210 offset1:211
v_mfma_f32_16x16x32_bf16 v[36:39], v[68:71], v[112:115], v[36:39]
ds_read_b128 v[176:179], v8 offset:2176
v_mfma_f32_16x16x32_bf16 v[40:43], v[68:71], v[116:119], v[40:43]
ds_read_b128 v[180:183], v8 offset:2688
v_mfma_f32_16x16x32_bf16 v[44:47], v[68:71], v[120:123], v[44:47]
ds_read_b128 v[184:187], v8 offset:3200
v_mfma_f32_16x16x32_bf16 v[24:27], v[72:75], v[96:99], v[24:27]
ds_read_b128 v[188:191], v8 offset:3712
v_mfma_f32_16x16x32_bf16 v[28:31], v[72:75], v[100:103], v[28:31]
v_mfma_f32_16x16x32_bf16 v[32:35], v[72:75], v[104:107], v[32:35]
v_mfma_f32_16x16x32_bf16 v[36:39], v[72:75], v[108:111], v[36:39]
v_mfma_f32_16x16x32_bf16 v[40:43], v[72:75], v[112:115], v[40:43]
v_mfma_f32_16x16x32_bf16 v[44:47], v[72:75], v[116:119], v[44:47]
v_mfma_f32_16x16x32_bf16 v[28:31], v[76:79], v[96:99], v[28:31]
v_mfma_f32_16x16x32_bf16 v[32:35], v[76:79], v[100:103], v[32:35]
v_mfma_f32_16x16x32_bf16 v[36:39], v[76:79], v[104:107], v[36:39]
v_mfma_f32_16x16x32_bf16 v[40:43], v[76:79], v[108:111], v[40:43]
v_mfma_f32_16x16x32_bf16 v[44:47], v[76:79], v[112:115], v[44:47]
s_waitcnt lgkmcnt(0)
v_mfma_f32_16x16x32_bf16 v[16:19], v[128:131], v[160:163], v[16:19]
ds_read_b128 v[96:99], v8 offset:64
v_mfma_f32_16x16x32_bf16 v[20:23], v[128:131], v[164:167], v[20:23]
ds_read2_b32 v[64:65], v4 offset0:96 offset1:97
v_mfma_f32_16x16x32_bf16 v[24:27], v[128:131], v[168:171], v[24:27]
ds_read2_b32 v[66:67], v4 offset0:98 offset1:99
v_mfma_f32_16x16x32_bf16 v[28:31], v[128:131], v[172:175], v[28:31]
ds_read_b128 v[100:103], v8 offset:576
v_mfma_f32_16x16x32_bf16 v[32:35], v[128:131], v[176:179], v[32:35]
ds_read2_b32 v[68:69], v4 offset0:224 offset1:225
v_mfma_f32_16x16x32_bf16 v[36:39], v[128:131], v[180:183], v[36:39]
ds_read2_b32 v[70:71], v4 offset0:226 offset1:227
v_mfma_f32_16x16x32_bf16 v[40:43], v[128:131], v[184:187], v[40:43]
ds_read_b128 v[104:107], v8 offset:1088
v_mfma_f32_16x16x32_bf16 v[44:47], v[128:131], v[188:191], v[44:47]
ds_read2_b32 v[72:73], v5 offset0:96 offset1:97
v_mfma_f32_16x16x32_bf16 v[20:23], v[132:135], v[160:163], v[20:23]
ds_read2_b32 v[74:75], v5 offset0:98 offset1:99
v_mfma_f32_16x16x32_bf16 v[24:27], v[132:135], v[164:167], v[24:27]
ds_read_b128 v[108:111], v8 offset:1600
v_mfma_f32_16x16x32_bf16 v[28:31], v[132:135], v[168:171], v[28:31]
ds_read2_b32 v[76:77], v5 offset0:224 offset1:225
v_mfma_f32_16x16x32_bf16 v[32:35], v[132:135], v[172:175], v[32:35]
ds_read2_b32 v[78:79], v5 offset0:226 offset1:227
v_mfma_f32_16x16x32_bf16 v[36:39], v[132:135], v[176:179], v[36:39]
ds_read_b128 v[112:115], v8 offset:2112
v_mfma_f32_16x16x32_bf16 v[40:43], v[132:135], v[180:183], v[40:43]
ds_read_b128 v[116:119], v8 offset:2624
v_mfma_f32_16x16x32_bf16 v[44:47], v[132:135], v[184:187], v[44:47]
ds_read_b128 v[120:123], v8 offset:3136
v_mfma_f32_16x16x32_bf16 v[24:27], v[136:139], v[160:163], v[24:27]
ds_read_b128 v[124:127], v8 offset:3648
v_mfma_f32_16x16x32_bf16 v[28:31], v[136:139], v[164:167], v[28:31]
v_mfma_f32_16x16x32_bf16 v[32:35], v[136:139], v[168:171], v[32:35]
v_mfma_f32_16x16x32_bf16 v[36:39], v[136:139], v[172:175], v[36:39]
v_mfma_f32_16x16x32_bf16 v[40:43], v[136:139], v[176:179], v[40:43]
v_mfma_f32_16x16x32_bf16 v[44:47], v[136:139], v[180:183], v[44:47]
v_mfma_f32_16x16x32_bf16 v[28:31], v[140:143], v[160:163], v[28:31]
v_mfma_f32_16x16x32_bf16 v[32:35], v[140:143], v[164:167], v[32:35]
v_mfma_f32_16x16x32_bf16 v[36:39], v[140:143], v[168:171], v[36:39]
v_mfma_f32_16x16x32_bf16 v[40:43], v[140:143], v[172:175], v[40:43]
v_mfma_f32_16x16x32_bf16 v[44:47], v[140:143], v[176:179], v[44:47]
s_waitcnt lgkmcnt(0)
v_mfma_f32_16x16x32_bf16 v[16:19], v[64:67], v[96:99], v[16:19]
ds_read_b128 v[160:163], v8 offset:0
v_mfma_f32_16x16x32_bf16 v[20:23], v[64:67], v[100:103], v[20:23]
ds_read2_b32 v[128:129], v4 offset0:112 offset1:113
v_mfma_f32_16x16x32_bf16 v[24:27], v[64:67], v[104:107], v[24:27]
ds_read2_b32 v[130:131], v4 offset0:114 offset1:115
v_mfma_f32_16x16x32_bf16 v[28:31], v[64:67], v[108:111], v[28:31]
ds_read_b128 v[164:167], v8 offset:512
v_mfma_f32_16x16x32_bf16 v[32:35], v[64:67], v[112:115], v[32:35]
ds_read2_b32 v[132:133], v4 offset0:240 offset1:241
v_mfma_f32_16x16x32_bf16 v[36:39], v[64:67], v[116:119], v[36:39]
ds_read2_b32 v[134:135], v4 offset0:242 offset1:243
v_mfma_f32_16x16x32_bf16 v[40:43], v[64:67], v[120:123], v[40:43]
ds_read_b128 v[168:171], v8 offset:1024
v_mfma_f32_16x16x32_bf16 v[44:47], v[64:67], v[124:127], v[44:47]
ds_read2_b32 v[136:137], v5 offset0:112 offset1:113
v_mfma_f32_16x16x32_bf16 v[20:23], v[68:71], v[96:99], v[20:23]
ds_read2_b32 v[138:139], v5 offset0:114 offset1:115
v_mfma_f32_16x16x32_bf16 v[24:27], v[68:71], v[100:103], v[24:27]
ds_read_b128 v[172:175], v8 offset:1536
v_mfma_f32_16x16x32_bf16 v[28:31], v[68:71], v[104:107], v[28:31]
ds_read2_b32 v[140:141], v5 offset0:240 offset1:241
v_mfma_f32_16x16x32_bf16 v[32:35], v[68:71], v[108:111], v[32:35]
ds_read2_b32 v[142:143], v5 offset0:242 offset1:243
v_mfma_f32_16x16x32_bf16 v[36:39], v[68:71], v[112:115], v[36:39]
ds_read_b128 v[176:179], v8 offset:2048
v_mfma_f32_16x16x32_bf16 v[40:43], v[68:71], v[116:119], v[40:43]
ds_read_b128 v[180:183], v8 offset:2560
v_mfma_f32_16x16x32_bf16 v[44:47], v[68:71], v[120:123], v[44:47]
ds_read_b128 v[184:187], v8 offset:3072
v_mfma_f32_16x16x32_bf16 v[24:27], v[72:75], v[96:99], v[24:27]
ds_read_b128 v[188:191], v8 offset:3584
v_mfma_f32_16x16x32_bf16 v[28:31], v[72:75], v[100:103], v[28:31]
v_mfma_f32_16x16x32_bf16 v[32:35], v[72:75], v[104:107], v[32:35]
v_mfma_f32_16x16x32_bf16 v[36:39], v[72:75], v[108:111], v[36:39]
v_mfma_f32_16x16x32_bf16 v[40:43], v[72:75], v[112:115], v[40:43]
v_mfma_f32_16x16x32_bf16 v[44:47], v[72:75], v[116:119], v[44:47]
v_mfma_f32_16x16x32_bf16 v[28:31], v[76:79], v[96:99], v[28:31]
v_mfma_f32_16x16x32_bf16 v[32:35], v[76:79], v[100:103], v[32:35]
v_mfma_f32_16x16x32_bf16 v[36:39], v[76:79], v[104:107], v[36:39]
v_mfma_f32_16x16x32_bf16 v[40:43], v[76:79], v[108:111], v[40:43]
v_mfma_f32_16x16x32_bf16 v[44:47], v[76:79], v[112:115], v[44:47]
s_waitcnt lgkmcnt(0)
v_mfma_f32_16x16x32_bf16 v[16:19], v[128:131], v[160:163], v[16:19]
ds_read_b128 v[96:99], v8 offset:448
v_mfma_f32_16x16x32_bf16 v[20:23], v[128:131], v[164:167], v[20:23]
ds_read2_b32 v[64:65], v6 offset0:0 offset1:1
ds_read2_b32 v[66:67], v6 offset0:2 offset1:3
v_mfma_f32_16x16x32_bf16 v[24:27], v[128:131], v[168:171], v[24:27]
ds_read_b128 v[100:103], v8 offset:960
v_mfma_f32_16x16x32_bf16 v[28:31], v[128:131], v[172:175], v[28:31]
ds_read2_b32 v[68:69], v6 offset0:128 offset1:129
ds_read2_b32 v[70:71], v6 offset0:130 offset1:131
v_mfma_f32_16x16x32_bf16 v[32:35], v[128:131], v[176:179], v[32:35]
ds_read_b128 v[104:107], v8 offset:1472
v_mfma_f32_16x16x32_bf16 v[36:39], v[128:131], v[180:183], v[36:39]
ds_read2_b32 v[72:73], v7 offset0:0 offset1:1
ds_read2_b32 v[74:75], v7 offset0:2 offset1:3
v_mfma_f32_16x16x32_bf16 v[40:43], v[128:131], v[184:187], v[40:43]
ds_read_b128 v[108:111], v8 offset:1984
v_mfma_f32_16x16x32_bf16 v[44:47], v[128:131], v[188:191], v[44:47]
ds_read2_b32 v[76:77], v7 offset0:128 offset1:129
ds_read2_b32 v[78:79], v7 offset0:130 offset1:131
v_mfma_f32_16x16x32_bf16 v[20:23], v[132:135], v[160:163], v[20:23]
ds_read_b128 v[112:115], v8 offset:384
v_mfma_f32_16x16x32_bf16 v[24:27], v[132:135], v[164:167], v[24:27]
ds_read2_b32 v[80:81], v6 offset0:16 offset1:17
ds_read2_b32 v[82:83], v6 offset0:18 offset1:19
v_mfma_f32_16x16x32_bf16 v[28:31], v[132:135], v[168:171], v[28:31]
ds_read_b128 v[116:119], v8 offset:896
v_mfma_f32_16x16x32_bf16 v[32:35], v[132:135], v[172:175], v[32:35]
ds_read2_b32 v[84:85], v6 offset0:144 offset1:145
ds_read2_b32 v[86:87], v6 offset0:146 offset1:147
v_mfma_f32_16x16x32_bf16 v[36:39], v[132:135], v[176:179], v[36:39]
ds_read_b128 v[120:123], v8 offset:1408
v_mfma_f32_16x16x32_bf16 v[40:43], v[132:135], v[180:183], v[40:43]
ds_read2_b32 v[88:89], v7 offset0:16 offset1:17
ds_read2_b32 v[90:91], v7 offset0:18 offset1:19
v_mfma_f32_16x16x32_bf16 v[44:47], v[132:135], v[184:187], v[44:47]
ds_read_b128 v[124:127], v8 offset:1920
v_mfma_f32_16x16x32_bf16 v[24:27], v[136:139], v[160:163], v[24:27]
ds_read2_b32 v[92:93], v7 offset0:144 offset1:145
ds_read2_b32 v[94:95], v7 offset0:146 offset1:147
v_mfma_f32_16x16x32_bf16 v[28:31], v[136:139], v[164:167], v[28:31]
v_mfma_f32_16x16x32_bf16 v[32:35], v[136:139], v[168:171], v[32:35]
v_mfma_f32_16x16x32_bf16 v[36:39], v[136:139], v[172:175], v[36:39]
v_mfma_f32_16x16x32_bf16 v[40:43], v[136:139], v[176:179], v[40:43]
v_mfma_f32_16x16x32_bf16 v[44:47], v[136:139], v[180:183], v[44:47]
v_mfma_f32_16x16x32_bf16 v[28:31], v[140:143], v[160:163], v[28:31]
v_mfma_f32_16x16x32_bf16 v[32:35], v[140:143], v[164:167], v[32:35]
v_mfma_f32_16x16x32_bf16 v[36:39], v[140:143], v[168:171], v[36:39]
v_mfma_f32_16x16x32_bf16 v[40:43], v[140:143], v[172:175], v[40:43]
v_mfma_f32_16x16x32_bf16 v[44:47], v[140:143], v[176:179], v[44:47]
s_waitcnt lgkmcnt(0)
v_mfma_f32_16x16x32_bf16 v[40:43], v[64:67], v[104:107], v[40:43]
v_cvt_pk_bf16_f32 v48, v16, v17
v_cvt_pk_bf16_f32 v49, v18, v19
ds_write_b64 v9, v[48:49] offset:20480
v_cvt_pk_bf16_f32 v50, v20, v21
v_cvt_pk_bf16_f32 v51, v22, v23
ds_write_b64 v9, v[50:51] offset:20992
v_mfma_f32_16x16x32_bf16 v[44:47], v[64:67], v[108:111], v[44:47]
v_cvt_pk_bf16_f32 v52, v24, v25
v_cvt_pk_bf16_f32 v53, v26, v27
ds_write_b64 v9, v[52:53] offset:21504
v_cvt_pk_bf16_f32 v54, v28, v29
v_cvt_pk_bf16_f32 v55, v30, v31
ds_write_b64 v9, v[54:55] offset:22016
v_mfma_f32_16x16x32_bf16 v[36:39], v[64:67], v[100:103], v[36:39]
ds_read_b128 v[160:163], v8 offset:320
ds_read2_b32 v[128:129], v6 offset0:32 offset1:33
v_mfma_f32_16x16x32_bf16 v[32:35], v[64:67], v[96:99], v[32:35]
ds_read2_b32 v[130:131], v6 offset0:34 offset1:35
ds_read_b128 v[164:167], v8 offset:832
v_mfma_f32_16x16x32_bf16 v[44:47], v[68:71], v[104:107], v[44:47]
ds_read2_b32 v[132:133], v6 offset0:160 offset1:161
ds_read2_b32 v[134:135], v6 offset0:162 offset1:163
v_mfma_f32_16x16x32_bf16 v[40:43], v[68:71], v[100:103], v[40:43]
ds_read_b128 v[168:171], v8 offset:1344
ds_read2_b32 v[136:137], v7 offset0:32 offset1:33
v_mfma_f32_16x16x32_bf16 v[36:39], v[68:71], v[96:99], v[36:39]
ds_read2_b32 v[138:139], v7 offset0:34 offset1:35
ds_read_b128 v[172:175], v8 offset:1856
v_mfma_f32_16x16x32_bf16 v[44:47], v[72:75], v[100:103], v[44:47]
ds_read2_b32 v[140:141], v7 offset0:160 offset1:161
ds_read2_b32 v[142:143], v7 offset0:162 offset1:163
v_mfma_f32_16x16x32_bf16 v[40:43], v[72:75], v[96:99], v[40:43]
ds_read_b128 v[176:179], v8 offset:256
ds_read2_b32 v[144:145], v6 offset0:48 offset1:49
v_mfma_f32_16x16x32_bf16 v[44:47], v[76:79], v[96:99], v[44:47]
ds_read2_b32 v[146:147], v6 offset0:50 offset1:51
ds_read_b128 v[180:183], v8 offset:768
v_mfma_f32_16x16x32_bf16 v[40:43], v[80:83], v[120:123], v[40:43]
ds_read2_b32 v[148:149], v6 offset0:176 offset1:177
ds_read2_b32 v[150:151], v6 offset0:178 offset1:179
v_mfma_f32_16x16x32_bf16 v[44:47], v[80:83], v[124:127], v[44:47]
ds_read_b128 v[184:187], v8 offset:1280
ds_read2_b32 v[152:153], v7 offset0:48 offset1:49
v_mfma_f32_16x16x32_bf16 v[36:39], v[80:83], v[116:119], v[36:39]
ds_read2_b32 v[154:155], v7 offset0:50 offset1:51
ds_read_b128 v[188:191], v8 offset:1792
v_mfma_f32_16x16x32_bf16 v[32:35], v[80:83], v[112:115], v[32:35]
ds_read2_b32 v[156:157], v7 offset0:176 offset1:177
ds_read2_b32 v[158:159], v7 offset0:178 offset1:179
v_mfma_f32_16x16x32_bf16 v[44:47], v[84:87], v[120:123], v[44:47]
v_mfma_f32_16x16x32_bf16 v[40:43], v[84:87], v[116:119], v[40:43]
v_mfma_f32_16x16x32_bf16 v[36:39], v[84:87], v[112:115], v[36:39]
v_mfma_f32_16x16x32_bf16 v[44:47], v[88:91], v[116:119], v[44:47]
v_mfma_f32_16x16x32_bf16 v[40:43], v[88:91], v[112:115], v[40:43]
v_mfma_f32_16x16x32_bf16 v[44:47], v[92:95], v[112:115], v[44:47]
s_waitcnt lgkmcnt(0)
s_barrier
v_mfma_f32_16x16x32_bf16 v[40:43], v[128:131], v[168:171], v[40:43]
ds_read_b128 v[96:99], v8 offset:192
v_mfma_f32_16x16x32_bf16 v[44:47], v[128:131], v[172:175], v[44:47]
ds_read2_b32 v[64:65], v6 offset0:64 offset1:65
ds_read2_b32 v[66:67], v6 offset0:66 offset1:67
v_mfma_f32_16x16x32_bf16 v[36:39], v[128:131], v[164:167], v[36:39]
ds_read_b128 v[100:103], v8 offset:704
v_mfma_f32_16x16x32_bf16 v[32:35], v[128:131], v[160:163], v[32:35]
ds_read2_b32 v[68:69], v6 offset0:192 offset1:193
ds_read2_b32 v[70:71], v6 offset0:194 offset1:195
v_mfma_f32_16x16x32_bf16 v[44:47], v[132:135], v[168:171], v[44:47]
ds_read_b128 v[104:107], v8 offset:1216
v_mfma_f32_16x16x32_bf16 v[40:43], v[132:135], v[164:167], v[40:43]
ds_read2_b32 v[72:73], v7 offset0:64 offset1:65
ds_read2_b32 v[74:75], v7 offset0:66 offset1:67
v_mfma_f32_16x16x32_bf16 v[36:39], v[132:135], v[160:163], v[36:39]
ds_read_b128 v[108:111], v8 offset:1728
v_mfma_f32_16x16x32_bf16 v[44:47], v[136:139], v[164:167], v[44:47]
ds_read2_b32 v[76:77], v7 offset0:192 offset1:193
ds_read2_b32 v[78:79], v7 offset0:194 offset1:195
v_mfma_f32_16x16x32_bf16 v[40:43], v[136:139], v[160:163], v[40:43]
ds_read_b128 v[112:115], v8 offset:128
v_mfma_f32_16x16x32_bf16 v[44:47], v[140:143], v[160:163], v[44:47]
ds_read2_b32 v[80:81], v6 offset0:80 offset1:81
ds_read2_b32 v[82:83], v6 offset0:82 offset1:83
v_mfma_f32_16x16x32_bf16 v[40:43], v[144:147], v[184:187], v[40:43]
ds_read_b128 v[116:119], v8 offset:640
v_mfma_f32_16x16x32_bf16 v[44:47], v[144:147], v[188:191], v[44:47]
ds_read2_b32 v[84:85], v6 offset0:208 offset1:209
ds_read2_b32 v[86:87], v6 offset0:210 offset1:211
v_mfma_f32_16x16x32_bf16 v[36:39], v[144:147], v[180:183], v[36:39]
ds_read_b128 v[120:123], v8 offset:1152
v_mfma_f32_16x16x32_bf16 v[32:35], v[144:147], v[176:179], v[32:35]
ds_read2_b32 v[88:89], v7 offset0:80 offset1:81
ds_read2_b32 v[90:91], v7 offset0:82 offset1:83
v_mfma_f32_16x16x32_bf16 v[44:47], v[148:151], v[184:187], v[44:47]
ds_read_b128 v[124:127], v8 offset:1664
v_mfma_f32_16x16x32_bf16 v[40:43], v[148:151], v[180:183], v[40:43]
ds_read2_b32 v[92:93], v7 offset0:208 offset1:209
ds_read2_b32 v[94:95], v7 offset0:210 offset1:211
v_mfma_f32_16x16x32_bf16 v[36:39], v[148:151], v[176:179], v[36:39]
v_mfma_f32_16x16x32_bf16 v[44:47], v[152:155], v[180:183], v[44:47]
v_mfma_f32_16x16x32_bf16 v[40:43], v[152:155], v[176:179], v[40:43]
v_mfma_f32_16x16x32_bf16 v[44:47], v[156:159], v[176:179], v[44:47]
s_waitcnt lgkmcnt(0)
v_mfma_f32_16x16x32_bf16 v[40:43], v[64:67], v[104:107], v[40:43]
ds_read_b128 v[160:163], v8 offset:64
v_mfma_f32_16x16x32_bf16 v[44:47], v[64:67], v[108:111], v[44:47]
ds_read2_b32 v[128:129], v6 offset0:96 offset1:97
ds_read2_b32 v[130:131], v6 offset0:98 offset1:99
v_mfma_f32_16x16x32_bf16 v[36:39], v[64:67], v[100:103], v[36:39]
ds_read_b128 v[164:167], v8 offset:576
v_mfma_f32_16x16x32_bf16 v[32:35], v[64:67], v[96:99], v[32:35]
ds_read2_b32 v[132:133], v6 offset0:224 offset1:225
ds_read2_b32 v[134:135], v6 offset0:226 offset1:227
v_mfma_f32_16x16x32_bf16 v[44:47], v[68:71], v[104:107], v[44:47]
ds_read_b128 v[168:171], v8 offset:1088
v_mfma_f32_16x16x32_bf16 v[40:43], v[68:71], v[100:103], v[40:43]
ds_read2_b32 v[136:137], v7 offset0:96 offset1:97
ds_read2_b32 v[138:139], v7 offset0:98 offset1:99
v_mfma_f32_16x16x32_bf16 v[36:39], v[68:71], v[96:99], v[36:39]
ds_read_b128 v[172:175], v8 offset:1600
v_mfma_f32_16x16x32_bf16 v[44:47], v[72:75], v[100:103], v[44:47]
ds_read2_b32 v[140:141], v7 offset0:224 offset1:225
ds_read2_b32 v[142:143], v7 offset0:226 offset1:227
v_mfma_f32_16x16x32_bf16 v[40:43], v[72:75], v[96:99], v[40:43]
ds_read_b128 v[176:179], v8 offset:0
v_mfma_f32_16x16x32_bf16 v[44:47], v[76:79], v[96:99], v[44:47]
ds_read2_b32 v[144:145], v6 offset0:112 offset1:113
ds_read2_b32 v[146:147], v6 offset0:114 offset1:115
v_mfma_f32_16x16x32_bf16 v[40:43], v[80:83], v[120:123], v[40:43]
ds_read_b128 v[180:183], v8 offset:512
v_mfma_f32_16x16x32_bf16 v[44:47], v[80:83], v[124:127], v[44:47]
ds_read2_b32 v[148:149], v6 offset0:240 offset1:241
ds_read2_b32 v[150:151], v6 offset0:242 offset1:243
v_mfma_f32_16x16x32_bf16 v[36:39], v[80:83], v[116:119], v[36:39]
ds_read_b128 v[184:187], v8 offset:1024
v_mfma_f32_16x16x32_bf16 v[32:35], v[80:83], v[112:115], v[32:35]
ds_read2_b32 v[152:153], v7 offset0:112 offset1:113
ds_read2_b32 v[154:155], v7 offset0:114 offset1:115
v_mfma_f32_16x16x32_bf16 v[44:47], v[84:87], v[120:123], v[44:47]
ds_read_b128 v[188:191], v8 offset:1536
v_mfma_f32_16x16x32_bf16 v[40:43], v[84:87], v[116:119], v[40:43]
ds_read2_b32 v[156:157], v7 offset0:240 offset1:241
ds_read2_b32 v[158:159], v7 offset0:242 offset1:243
v_mfma_f32_16x16x32_bf16 v[36:39], v[84:87], v[112:115], v[36:39]
v_mfma_f32_16x16x32_bf16 v[44:47], v[88:91], v[116:119], v[44:47]
v_mfma_f32_16x16x32_bf16 v[40:43], v[88:91], v[112:115], v[40:43]
v_mfma_f32_16x16x32_bf16 v[44:47], v[92:95], v[112:115], v[44:47]
s_waitcnt lgkmcnt(0)
v_mfma_f32_16x16x32_bf16 v[40:43], v[128:131], v[168:171], v[40:43]
v_mfma_f32_16x16x32_bf16 v[44:47], v[128:131], v[172:175], v[44:47]
v_mfma_f32_16x16x32_bf16 v[36:39], v[128:131], v[164:167], v[36:39]
v_mfma_f32_16x16x32_bf16 v[32:35], v[128:131], v[160:163], v[32:35]
v_mfma_f32_16x16x32_bf16 v[44:47], v[132:135], v[168:171], v[44:47]
v_mfma_f32_16x16x32_bf16 v[40:43], v[132:135], v[164:167], v[40:43]
v_mfma_f32_16x16x32_bf16 v[36:39], v[132:135], v[160:163], v[36:39]
v_mfma_f32_16x16x32_bf16 v[44:47], v[136:139], v[164:167], v[44:47]
v_mfma_f32_16x16x32_bf16 v[40:43], v[136:139], v[160:163], v[40:43]
v_mfma_f32_16x16x32_bf16 v[44:47], v[140:143], v[160:163], v[44:47]
v_mfma_f32_16x16x32_bf16 v[40:43], v[144:147], v[184:187], v[40:43]
v_mfma_f32_16x16x32_bf16 v[44:47], v[144:147], v[188:191], v[44:47]
v_mfma_f32_16x16x32_bf16 v[36:39], v[144:147], v[180:183], v[36:39]
v_mfma_f32_16x16x32_bf16 v[32:35], v[144:147], v[176:179], v[32:35]
v_mfma_f32_16x16x32_bf16 v[44:47], v[148:151], v[184:187], v[44:47]
v_mfma_f32_16x16x32_bf16 v[40:43], v[148:151], v[180:183], v[40:43]
v_mfma_f32_16x16x32_bf16 v[36:39], v[148:151], v[176:179], v[36:39]
v_mfma_f32_16x16x32_bf16 v[44:47], v[152:155], v[180:183], v[44:47]
v_mfma_f32_16x16x32_bf16 v[40:43], v[152:155], v[176:179], v[40:43]
v_mfma_f32_16x16x32_bf16 v[44:47], v[156:159], v[176:179], v[44:47]
s_nop 1
v_cvt_pk_bf16_f32 v56, v32, v33
v_cvt_pk_bf16_f32 v57, v34, v35
ds_write_b64 v9, v[56:57] offset:22528
v_cvt_pk_bf16_f32 v58, v36, v37
v_cvt_pk_bf16_f32 v59, v38, v39
ds_write_b64 v9, v[58:59] offset:23040
v_cvt_pk_bf16_f32 v60, v40, v41
v_cvt_pk_bf16_f32 v61, v42, v43
ds_write_b64 v9, v[60:61] offset:23552
v_cvt_pk_bf16_f32 v62, v44, v45
v_cvt_pk_bf16_f32 v63, v46, v47
ds_write_b64 v9, v[62:63] offset:24064
s_branch L_B3
L_B4:
s_mov_b32 s44, s10
s_mov_b32 s45, s11
s_mov_b32 s46, 0x80000
s_mov_b32 s47, 0x20000
s_and_b32 s74, s2, 0x78
s_lshl_b32 s74, s74, 12
s_lshl_b32 s75, s66, 13
s_add_u32 s74, s74, s75
v_lshlrev_b32 v201, 7, v1
buffer_load_dword v202, v201, s[44:47], s74 offen
s_mov_b32 s76, s30
s_mov_b32 s77, s31
s_mov_b32 s78, 0x300000
s_mov_b32 s79, 0x20000
s_lshl2_add_u32 s74, s2, s66
s_lshl_b32 s74, s74, 12
s_sub_u32 s74, s74, 0x100000
v_lshlrev_b32 v210, 4, v1
v_mov_b32 v204, -1
v_mov_b32 v205, -1
v_mov_b32 v206, -1
v_mov_b32 v207, -1
buffer_store_dwordx4 v[204:207], v210, s[76:79], s74 offen offset:0 sc1
buffer_store_dwordx4 v[204:207], v210, s[76:79], s74 offen offset:1024 sc1
buffer_store_dwordx4 v[204:207], v210, s[76:79], s74 offen offset:2048 sc1
buffer_store_dwordx4 v[204:207], v210, s[76:79], s74 offen offset:3072 sc1
s_mov_b32 s40, s28
s_mov_b32 s41, s29
s_mov_b32 s42, 0x100
s_mov_b32 s43, 0x20000
s_mov_b32 s36, s30
s_mov_b32 s37, s31
s_mov_b32 s38, 0x300000
s_mov_b32 s39, 0x20000
s_and_b32 s75, s2, 4
s_lshl_b32 s75, s75, 5
v_mov_b32 v10, 0
s_lshl2_add_u32 s74, s2, s66
s_lshl_b32 s74, s74, 4
s_add_u32 s74, s74, 0x9e000
s_mov_b32 s3, 0x10000
s_mov_b64 exec, 1
buffer_load_dword v9, v10, s[40:43], s75 offen
L_B8:
s_waitcnt vmcnt(0)
v_cmp_gt_u32 vcc, 64, v9
s_cbranch_vccz L_B9
buffer_load_dword v9, v10, s[40:43], s75 offen sc1
s_sub_u32 s3, s3, 1
s_cbranch_scc0 L_B8
L_B9:
buffer_store_dword v10, v10, s[36:39], s74 offen sc1
s_mov_b64 exec, -1
L_B3:
v_xor_b32 v0, 0x100, v0
v_lshlrev_b32 v18, 3, v0
v_lshl_add_u32 v3, v0, 13, s64
v_add_u32 v4, 0x1000, v3
s_waitcnt lgkmcnt(0)
s_barrier
ds_read_b64 v[8:9], v18 offset:20480
ds_read_b64 v[10:11], v18 offset:24576
ds_read_b64 v[12:13], v18 offset:28672
ds_read_b64 v[14:15], v18 offset:32768
s_waitcnt lgkmcnt(0)
v_perm_b32 v20, v10, v8, s72
v_perm_b32 v21, v14, v12, s72
buffer_store_dwordx2 v[20:21], v3, s[52:55], 0 offen offset:1024
v_perm_b32 v22, v10, v8, s73
v_perm_b32 v23, v14, v12, s73
buffer_store_dwordx2 v[22:23], v3, s[52:55], 0 offen offset:3072
v_perm_b32 v24, v11, v9, s72
v_perm_b32 v25, v15, v13, s72
buffer_store_dwordx2 v[24:25], v4, s[52:55], 0 offen offset:1024
v_perm_b32 v26, v11, v9, s73
v_perm_b32 v27, v15, v13, s73
buffer_store_dwordx2 v[26:27], v4, s[52:55], 0 offen offset:3072
s_cmp_lt_u32 s70, 4
s_cbranch_scc1 L_B5
s_barrier
L_B5:
s_endpgm
L_END:
s_endpgm
.section .rodata,"a"
.p2align 6
.amdhsa_kernel concat_heads__linear_kernel_hedgehog__ssm_conv_s4d__prompt_kernel
  .amdhsa_next_free_vgpr 256
  .amdhsa_next_free_sgpr 102
  .amdhsa_accum_offset 256
  .amdhsa_group_segment_fixed_size 0
  .amdhsa_kernarg_size 112
  .amdhsa_user_sgpr_count 2
  .amdhsa_user_sgpr_kernarg_segment_ptr 1
  .amdhsa_system_sgpr_workgroup_id_x 1
.end_amdhsa_kernel
```
